```python
import torch

def _softmax(x, axis=-1):
    return torch.softmax(x, dim=axis)
def _gelu(x):
    return torch.nn.functional.gelu(x, approximate="tanh")
def _silu(x):
    return torch.nn.functional.silu(x)
def _sigmoid(x):
    return torch.sigmoid(x)
def _layernorm(x, axis=-1, eps=1e-5):
    m = x.mean(dim=axis, keepdim=True)
    v = x.var(dim=axis, keepdim=True, unbiased=False)
    return (x - m) / torch.sqrt(v + eps)
def _scatter_add(tgt, idx, src, axis=0):
    return tgt.clone().index_add_(axis, idx, src)
def _segment_sum(src, seg, n):
    out = torch.zeros((n,) + src.shape[1:], dtype=src.dtype)
    return out.index_add_(0, seg, src)
def _pad(x, pw):
    flat = tuple(v for pair in reversed(pw) for v in pair)
    return torch.nn.functional.pad(x, flat)

kernel_name = 'gather_scatter__edge_featured_mpnn_gatedgcn__graph'

def setup_inputs():

    _w = (lambda a: (lambda t: t.to(torch.bfloat16) if t.is_floating_point() else t)(torch.as_tensor(a)))
    N, deg, D, De = 10000, 16, 256, max(0, 1)
    E = N * deg
    return {
        "x": _w((lambda *s: torch.randn(*s, dtype=torch.bfloat16) * 0.4)(N, D)),
        "e_attr": _w((lambda *s: torch.randn(*s, dtype=torch.bfloat16) * 0.8)(E, De)),
        "src": _w((lambda lo, hi, *s: torch.randint(lo, hi, s))(0, N, E).to(torch.int64)),
        "dst": _w((lambda lo, hi, *s: torch.randint(lo, hi, s))(0, N, E).to(torch.int64)),
        "w_a": _w((lambda *s: torch.randn(*s, dtype=torch.bfloat16) * 0.4)(D, D)),
        "w_b": _w((lambda *s: torch.randn(*s, dtype=torch.bfloat16) * 0.4)(D, D)),
        "w_c": _w((lambda *s: torch.randn(*s, dtype=torch.bfloat16) * 0.8)(De, D)),
        "w_u": _w((lambda *s: torch.randn(*s, dtype=torch.bfloat16) * 0.05)(D, D)),
        "w_v": _w((lambda *s: torch.randn(*s, dtype=torch.bfloat16) * 0.05)(D, D)),
    }

def reference(x, e_attr, src, dst, w_a, w_b, w_c, w_u, w_v):
    N, D = x.shape
    hv = x @ w_v
    g = x[dst] @ w_a + x[src] @ w_b + e_attr @ w_c
    eta = _sigmoid(g)
    denom = _segment_sum(eta, dst, N) + 1e-6
    eta_n = eta / denom[dst]
    agg = _segment_sum(eta_n * hv[src], dst, N)
    z = x @ w_u + agg
    relu_z = torch.where(z > 0, z, 0 * z)
    return x + relu_z
```

```asm
; @launch grid=(256,1,1) block=(1024,1,1) lds=163840
.amdgcn_target "amdgcn-amd-amdhsa--gfx950"
.text
.globl gather_scatter__edge_featured_mpnn_gatedgcn__graph_kernel
.p2align 8
.type gather_scatter__edge_featured_mpnn_gatedgcn__graph_kernel,@function
gather_scatter__edge_featured_mpnn_gatedgcn__graph_kernel:
  s_cmp_ge_u32 s2, 256
  s_cbranch_scc1 END_206
  s_load_dwordx16 s[4:19], s[0:1], 0
  s_load_dwordx8 s[20:27], s[0:1], 64
  v_readfirstlane_b32 s3, v0
  v_and_b32 v1, 63, v0
  v_mov_b32 v124, 0
  v_mov_b32 v125, 1
  s_and_b32 s54, s2, 7
  s_lshr_b32 s53, s54, 1
  s_and_b32 s54, s54, 1
  s_lshr_b32 s52, s2, 3
  s_lshl_b32 s52, s52, 1
  s_or_b32 s52, s52, s54
  s_lshr_b32 s93, s2, 3
  s_lshr_b32 s54, s93, 2
  s_lshl_b32 s54, s54, 3
  s_and_b32 s92, s2, 7
  s_add_u32 s92, s92, s54
  s_and_b32 s93, s93, 3
  s_lshr_b32 s3, s3, 6
  s_add_u32 s48, s53, 0
  s_and_b32 s48, s48, 3
  s_add_u32 s49, s53, 1
  s_and_b32 s49, s49, 3
  s_add_u32 s50, s53, 2
  s_and_b32 s50, s50, 3
  s_add_u32 s51, s53, 3
  s_and_b32 s51, s51, 3
  s_mov_b32 s92, s52
  s_mov_b32 s93, s53
  s_cmp_eq_u32 s3, 13
  s_cbranch_scc0 CT_208
  s_getpc_b64 s[94:95]
PC_209:
  v_lshlrev_b32 v4, 7, v1
  s_mov_b32 s96, KCODE_END - PC_209 - 4
  v_cmp_gt_u32 vcc, s96, v4
  s_mov_b64 exec, vcc
  s_cbranch_execz CTS_210
  global_load_dword v100, v4, s[94:95]
CTS_210:
  s_mov_b64 exec, -1
  v_add_u32 v4, 0x2000, v4
  v_cmp_gt_u32 vcc, s96, v4
  s_mov_b64 exec, vcc
  s_cbranch_execz CTS_211
  global_load_dword v101, v4, s[94:95]
CTS_211:
  s_mov_b64 exec, -1
  v_add_u32 v4, 0x2000, v4
  v_cmp_gt_u32 vcc, s96, v4
  s_mov_b64 exec, vcc
  s_cbranch_execz CTS_212
  global_load_dword v102, v4, s[94:95]
CTS_212:
  s_mov_b64 exec, -1
  v_add_u32 v4, 0x2000, v4
CT_208:
  s_cmp_lt_u32 s3, 2
  s_cbranch_scc0 NZ_217
  v_lshlrev_b32 v4, 4, v1
  s_lshl_b32 s54, s3, 10
  v_add_u32 v4, s54, v4
  v_mov_b32 v8, 0
  v_mov_b32 v9, 0
  v_mov_b32 v10, 0
  v_mov_b32 v11, 0
  v_cmp_gt_u32 vcc, 1536, v4
  s_mov_b64 exec, vcc
  ds_write_b128 v4, v[8:11]
  s_mov_b64 exec, -1
NZ_217:
  s_cmp_ge_u32 s3, 14
  s_cbranch_scc0 IM_218
  s_setprio 3
  s_waitcnt lgkmcnt(0)
  s_mov_b32 s28, s10
  s_and_b32 s29, s11, 0xffff
  s_mov_b32 s30, 640000
  s_mov_b32 s31, 0x00020000
  s_mov_b32 s32, s8
  s_and_b32 s33, s9, 0xffff
  s_mov_b32 s34, 640000
  s_mov_b32 s35, 0x00020000
  s_mov_b32 s36, s6
  s_and_b32 s37, s7, 0xffff
  s_mov_b32 s38, 320000
  s_mov_b32 s39, 0x00020000
  s_sub_u32 s63, s3, 14
  v_lshlrev_b32 v34, 2, v1
  v_lshlrev_b32 v35, 1, v1
  s_mul_i32 s54, s2, 625
  s_mul_i32 s56, s63, 320
  s_add_u32 s54, s54, s56
  s_lshl_b32 s55, s54, 1
  s_lshl_b32 s54, s54, 2
  buffer_load_dword v8, v34, s[28:31], s54 offen offset:0
  buffer_load_dword v9, v34, s[28:31], s54 offen offset:256
  buffer_load_dword v10, v34, s[28:31], s54 offen offset:512
  buffer_load_dword v11, v34, s[28:31], s54 offen offset:768
  buffer_load_dword v12, v34, s[28:31], s54 offen offset:1024
  buffer_load_dword v13, v34, s[32:35], s54 offen offset:0
  buffer_load_dword v14, v34, s[32:35], s54 offen offset:256
  buffer_load_dword v15, v34, s[32:35], s54 offen offset:512
  buffer_load_dword v16, v34, s[32:35], s54 offen offset:768
  buffer_load_dword v17, v34, s[32:35], s54 offen offset:1024
  buffer_load_ushort v18, v35, s[36:39], s55 offen offset:0
  buffer_load_ushort v19, v35, s[36:39], s55 offen offset:128
  buffer_load_ushort v20, v35, s[36:39], s55 offen offset:256
  buffer_load_ushort v21, v35, s[36:39], s55 offen offset:384
  buffer_load_ushort v22, v35, s[36:39], s55 offen offset:512
  global_load_dword v40, v124, s[26:27] offset:0 sc1
  s_and_b32 s54, s2, 3
  s_lshl_b32 s54, s54, 3
  s_add_u32 s54, s54, 160
  v_and_b32 v64, 7, v1
  v_add_u32 v64, s54, v64
  v_mov_b32 v65, 0
  v_mov_b32 v66, v64
  v_mov_b32 v67, 0
  s_sub_u32 s54, s3, 14
  s_lshl_b32 s54, s54, 12
  v_lshlrev_b32 v4, 4, v1
  v_add_u32 v4, s54, v4
  ds_write_b128 v4, v[64:67] offset:1536
  ds_write_b128 v4, v[64:67] offset:2560
  ds_write_b128 v4, v[64:67] offset:3584
  ds_write_b128 v4, v[64:67] offset:4608
IM_218:
  s_waitcnt lgkmcnt(0)
  s_barrier
  s_cmp_lt_u32 s3, 10
  s_cbranch_scc1 GW_213
  s_cmp_ge_u32 s3, 14
  s_cbranch_scc1 W15_214
  v_lshrrev_b32 v4, 4, v1
  v_and_b32 v4, 1, v4
  v_lshlrev_b32 v4, 2, v4
  v_and_b32 v9, 7, v1
  v_xor_b32 v9, v9, v4
  v_lshlrev_b32 v9, 4, v9
  v_lshrrev_b32 v4, 3, v1
  v_lshlrev_b32 v4, 9, v4
  v_add_u32 v9, v9, v4
  s_sub_u32 s61, s3, 10
  s_lshl_b32 s54, s93, 7
  s_sub_u32 s55, 131072, s54
  s_add_u32 s56, s14, s54
  s_addc_u32 s57, s15, 0
  s_mov_b32 s32, s56
  s_and_b32 s33, s57, 0xffff
  s_mov_b32 s34, s55
  s_mov_b32 s35, 0x00020000
  s_add_u32 s56, s20, s54
  s_addc_u32 s57, s21, 0
  s_mov_b32 s36, s56
  s_and_b32 s37, s57, 0xffff
  s_mov_b32 s38, s55
  s_mov_b32 s39, 0x00020000
  s_lshl_b32 s62, s61, 10
  s_lshl_b32 s61, s61, 12
  s_add_u32 m0, s62, 98304
  s_lshl_b32 s54, s48, 15
  s_add_u32 s54, s54, s61
  s_add_u32 s54, s54, 0
  buffer_load_dwordx4 v9, s[32:35], s54 offen lds
  s_add_u32 m0, s62, 102400
  s_lshl_b32 s54, s48, 15
  s_add_u32 s54, s54, s61
  s_add_u32 s54, s54, 16384
  buffer_load_dwordx4 v9, s[32:35], s54 offen lds
  s_add_u32 m0, s62, 106496
  s_lshl_b32 s54, s48, 15
  s_add_u32 s54, s54, s61
  s_add_u32 s54, s54, 0
  buffer_load_dwordx4 v9, s[36:39], s54 offen lds
  s_add_u32 m0, s62, 110592
  s_lshl_b32 s54, s48, 15
  s_add_u32 s54, s54, s61
  s_add_u32 s54, s54, 16384
  buffer_load_dwordx4 v9, s[36:39], s54 offen lds
  s_add_u32 m0, s62, 114688
  s_lshl_b32 s54, s49, 15
  s_add_u32 s54, s54, s61
  s_add_u32 s54, s54, 0
  buffer_load_dwordx4 v9, s[32:35], s54 offen lds
  s_add_u32 m0, s62, 118784
  s_lshl_b32 s54, s49, 15
  s_add_u32 s54, s54, s61
  s_add_u32 s54, s54, 16384
  buffer_load_dwordx4 v9, s[32:35], s54 offen lds
  s_add_u32 m0, s62, 122880
  s_lshl_b32 s54, s49, 15
  s_add_u32 s54, s54, s61
  s_add_u32 s54, s54, 0
  buffer_load_dwordx4 v9, s[36:39], s54 offen lds
  s_add_u32 m0, s62, 126976
  s_lshl_b32 s54, s49, 15
  s_add_u32 s54, s54, s61
  s_add_u32 s54, s54, 16384
  buffer_load_dwordx4 v9, s[36:39], s54 offen lds
  s_waitcnt vmcnt(4)
  s_mov_b64 exec, 1
  ds_add_u32 v124, v125 offset:1028
  s_mov_b64 exec, -1
  s_add_u32 m0, s62, 131072
  s_lshl_b32 s54, s50, 15
  s_add_u32 s54, s54, s61
  s_add_u32 s54, s54, 0
  buffer_load_dwordx4 v9, s[32:35], s54 offen lds
  s_add_u32 m0, s62, 135168
  s_lshl_b32 s54, s50, 15
  s_add_u32 s54, s54, s61
  s_add_u32 s54, s54, 16384
  buffer_load_dwordx4 v9, s[32:35], s54 offen lds
  s_add_u32 m0, s62, 139264
  s_lshl_b32 s54, s50, 15
  s_add_u32 s54, s54, s61
  s_add_u32 s54, s54, 0
  buffer_load_dwordx4 v9, s[36:39], s54 offen lds
  s_add_u32 m0, s62, 143360
  s_lshl_b32 s54, s50, 15
  s_add_u32 s54, s54, s61
  s_add_u32 s54, s54, 16384
  buffer_load_dwordx4 v9, s[36:39], s54 offen lds
  s_add_u32 m0, s62, 147456
  s_lshl_b32 s54, s51, 15
  s_add_u32 s54, s54, s61
  s_add_u32 s54, s54, 0
  buffer_load_dwordx4 v9, s[32:35], s54 offen lds
  s_add_u32 m0, s62, 151552
  s_lshl_b32 s54, s51, 15
  s_add_u32 s54, s54, s61
  s_add_u32 s54, s54, 16384
  buffer_load_dwordx4 v9, s[32:35], s54 offen lds
  s_add_u32 m0, s62, 155648
  s_lshl_b32 s54, s51, 15
  s_add_u32 s54, s54, s61
  s_add_u32 s54, s54, 0
  buffer_load_dwordx4 v9, s[36:39], s54 offen lds
  s_add_u32 m0, s62, 159744
  s_lshl_b32 s54, s51, 15
  s_add_u32 s54, s54, s61
  s_add_u32 s54, s54, 16384
  buffer_load_dwordx4 v9, s[36:39], s54 offen lds
  s_waitcnt vmcnt(8)
  s_mov_b64 exec, 1
  ds_add_u32 v124, v125 offset:1032
  s_mov_b64 exec, -1
  s_waitcnt vmcnt(4)
  s_mov_b64 exec, 1
  ds_add_u32 v124, v125 offset:1036
  s_mov_b64 exec, -1
  s_waitcnt vmcnt(0)
  s_mov_b64 exec, 1
  ds_add_u32 v124, v125 offset:1040
  s_mov_b64 exec, -1
  s_cmp_ge_u32 s3, 12
  s_cbranch_scc1 REC_215
  s_lshl_b32 s54, s53, 7
  s_sub_u32 s55, 131072, s54
  s_add_u32 s56, s12, s54
  s_addc_u32 s57, s13, 0
  s_mov_b32 s40, s56
  s_and_b32 s41, s57, 0xffff
  s_mov_b32 s42, s55
  s_mov_b32 s43, 0x00020000
  s_add_u32 s56, s18, s54
  s_addc_u32 s57, s19, 0
  s_mov_b32 s44, s56
  s_and_b32 s45, s57, 0xffff
  s_mov_b32 s46, s55
  s_mov_b32 s47, 0x00020000
  s_lshl_b32 s54, s50, 15
  s_add_u32 s54, s54, s61
  s_add_u32 s54, s54, 0
  buffer_load_dwordx4 v[32:35], v9, s[40:43], s54 offen
  s_lshl_b32 s54, s50, 15
  s_add_u32 s54, s54, s61
  s_add_u32 s54, s54, 8192
  buffer_load_dwordx4 v[36:39], v9, s[40:43], s54 offen
  s_lshl_b32 s54, s50, 15
  s_add_u32 s54, s54, s61
  s_add_u32 s54, s54, 16384
  buffer_load_dwordx4 v[40:43], v9, s[40:43], s54 offen
  s_lshl_b32 s54, s50, 15
  s_add_u32 s54, s54, s61
  s_add_u32 s54, s54, 24576
  buffer_load_dwordx4 v[44:47], v9, s[40:43], s54 offen
  s_lshl_b32 s54, s50, 15
  s_add_u32 s54, s54, s61
  s_add_u32 s54, s54, 0
  buffer_load_dwordx4 v[48:51], v9, s[44:47], s54 offen
  s_lshl_b32 s54, s50, 15
  s_add_u32 s54, s54, s61
  s_add_u32 s54, s54, 8192
  buffer_load_dwordx4 v[52:55], v9, s[44:47], s54 offen
  s_lshl_b32 s54, s50, 15
  s_add_u32 s54, s54, s61
  s_add_u32 s54, s54, 16384
  buffer_load_dwordx4 v[56:59], v9, s[44:47], s54 offen
  s_lshl_b32 s54, s50, 15
  s_add_u32 s54, s54, s61
  s_add_u32 s54, s54, 24576
  buffer_load_dwordx4 v[60:63], v9, s[44:47], s54 offen
  s_lshl_b32 s54, s51, 15
  s_add_u32 s54, s54, s61
  s_add_u32 s54, s54, 0
  buffer_load_dwordx4 v[64:67], v9, s[40:43], s54 offen
  s_lshl_b32 s54, s51, 15
  s_add_u32 s54, s54, s61
  s_add_u32 s54, s54, 8192
  buffer_load_dwordx4 v[68:71], v9, s[40:43], s54 offen
  s_lshl_b32 s54, s51, 15
  s_add_u32 s54, s54, s61
  s_add_u32 s54, s54, 16384
  buffer_load_dwordx4 v[72:75], v9, s[40:43], s54 offen
  s_lshl_b32 s54, s51, 15
  s_add_u32 s54, s54, s61
  s_add_u32 s54, s54, 24576
  buffer_load_dwordx4 v[76:79], v9, s[40:43], s54 offen
  s_lshl_b32 s54, s51, 15
  s_add_u32 s54, s54, s61
  s_add_u32 s54, s54, 0
  buffer_load_dwordx4 v[80:83], v9, s[44:47], s54 offen
  s_lshl_b32 s54, s51, 15
  s_add_u32 s54, s54, s61
  s_add_u32 s54, s54, 8192
  buffer_load_dwordx4 v[84:87], v9, s[44:47], s54 offen
  s_lshl_b32 s54, s51, 15
  s_add_u32 s54, s54, s61
  s_add_u32 s54, s54, 16384
  buffer_load_dwordx4 v[88:91], v9, s[44:47], s54 offen
  s_lshl_b32 s54, s51, 15
  s_add_u32 s54, s54, s61
  s_add_u32 s54, s54, 24576
  buffer_load_dwordx4 v[92:95], v9, s[44:47], s54 offen
  v_lshrrev_b32 v25, 2, v1
  v_and_b32 v26, 3, v1
  v_and_b32 v27, 1, v25
  v_mul_u32_u24 v27, 3, v27
  v_xor_b32 v26, v26, v27
  v_lshlrev_b32 v25, 1, v25
  s_mov_b32 s54, 784916
  v_lshrrev_b32 v27, v25, s54
  v_and_b32 v27, 3, v27
  s_mov_b32 s54, 672848
  v_lshrrev_b32 v28, v25, s54
  v_and_b32 v28, 3, v28
  v_lshrrev_b32 v25, 1, v27
  v_add_u32 v25, 2, v25
  v_mul_u32_u24 v26, v26, v25
  v_add_u32 v28, v28, v26
  v_lshl_add_u32 v28, v27, 3, v28
  v_cmp_eq_u32 vcc, 3, v27
  s_nop 1
  v_cndmask_b32 v25, 0, 4, vcc
  v_add_lshl_u32 v24, v28, v25, 2
  v_lshlrev_b32 v29, 4, v1
  v_add_u32 v29, s62, v29
  s_mov_b32 s60, 0
SPIN_219:
  ds_read_b32 v6, v124 offset:1060
  s_waitcnt lgkmcnt(0)
  v_readfirstlane_b32 s54, v6
  s_cmp_ge_u32 s54, 10
  s_cbranch_scc1 SPD_220
  s_add_u32 s60, s60, 1
  s_cmp_lt_u32 s60, 200000
  s_sleep 1
  s_cbranch_scc1 SPIN_219
  v_mov_b32 v6, 16
  ds_or_b32 v124, v6 offset:1024
SPD_220:
  s_add_u32 m0, s62, 98304
  s_lshl_b32 s54, s48, 15
  s_add_u32 s54, s54, s61
  s_add_u32 s54, s54, 0
  buffer_load_dwordx4 v9, s[40:43], s54 offen lds
  s_add_u32 m0, s62, 100352
  s_lshl_b32 s54, s48, 15
  s_add_u32 s54, s54, s61
  s_add_u32 s54, s54, 8192
  buffer_load_dwordx4 v9, s[40:43], s54 offen lds
  s_add_u32 m0, s62, 102400
  s_lshl_b32 s54, s48, 15
  s_add_u32 s54, s54, s61
  s_add_u32 s54, s54, 16384
  buffer_load_dwordx4 v9, s[40:43], s54 offen lds
  s_add_u32 m0, s62, 104448
  s_lshl_b32 s54, s48, 15
  s_add_u32 s54, s54, s61
  s_add_u32 s54, s54, 24576
  buffer_load_dwordx4 v9, s[40:43], s54 offen lds
  s_add_u32 m0, s62, 106496
  s_lshl_b32 s54, s48, 15
  s_add_u32 s54, s54, s61
  s_add_u32 s54, s54, 0
  buffer_load_dwordx4 v9, s[44:47], s54 offen lds
  s_add_u32 m0, s62, 108544
  s_lshl_b32 s54, s48, 15
  s_add_u32 s54, s54, s61
  s_add_u32 s54, s54, 8192
  buffer_load_dwordx4 v9, s[44:47], s54 offen lds
  s_add_u32 m0, s62, 110592
  s_lshl_b32 s54, s48, 15
  s_add_u32 s54, s54, s61
  s_add_u32 s54, s54, 16384
  buffer_load_dwordx4 v9, s[44:47], s54 offen lds
  s_add_u32 m0, s62, 112640
  s_lshl_b32 s54, s48, 15
  s_add_u32 s54, s54, s61
  s_add_u32 s54, s54, 24576
  buffer_load_dwordx4 v9, s[44:47], s54 offen lds
  s_mov_b32 s60, 0
SPIN_221:
  ds_read_b32 v6, v124 offset:1064
  s_waitcnt lgkmcnt(0)
  v_readfirstlane_b32 s54, v6
  s_cmp_ge_u32 s54, 10
  s_cbranch_scc1 SPD_222
  s_add_u32 s60, s60, 1
  s_cmp_lt_u32 s60, 200000
  s_sleep 1
  s_cbranch_scc1 SPIN_221
  v_mov_b32 v6, 16
  ds_or_b32 v124, v6 offset:1024
SPD_222:
  s_add_u32 m0, s62, 114688
  s_lshl_b32 s54, s49, 15
  s_add_u32 s54, s54, s61
  s_add_u32 s54, s54, 0
  buffer_load_dwordx4 v9, s[40:43], s54 offen lds
  s_add_u32 m0, s62, 116736
  s_lshl_b32 s54, s49, 15
  s_add_u32 s54, s54, s61
  s_add_u32 s54, s54, 8192
  buffer_load_dwordx4 v9, s[40:43], s54 offen lds
  s_add_u32 m0, s62, 118784
  s_lshl_b32 s54, s49, 15
  s_add_u32 s54, s54, s61
  s_add_u32 s54, s54, 16384
  buffer_load_dwordx4 v9, s[40:43], s54 offen lds
  s_add_u32 m0, s62, 120832
  s_lshl_b32 s54, s49, 15
  s_add_u32 s54, s54, s61
  s_add_u32 s54, s54, 24576
  buffer_load_dwordx4 v9, s[40:43], s54 offen lds
  s_add_u32 m0, s62, 122880
  s_lshl_b32 s54, s49, 15
  s_add_u32 s54, s54, s61
  s_add_u32 s54, s54, 0
  buffer_load_dwordx4 v9, s[44:47], s54 offen lds
  s_add_u32 m0, s62, 124928
  s_lshl_b32 s54, s49, 15
  s_add_u32 s54, s54, s61
  s_add_u32 s54, s54, 8192
  buffer_load_dwordx4 v9, s[44:47], s54 offen lds
  s_add_u32 m0, s62, 126976
  s_lshl_b32 s54, s49, 15
  s_add_u32 s54, s54, s61
  s_add_u32 s54, s54, 16384
  buffer_load_dwordx4 v9, s[44:47], s54 offen lds
  s_add_u32 m0, s62, 129024
  s_lshl_b32 s54, s49, 15
  s_add_u32 s54, s54, s61
  s_add_u32 s54, s54, 24576
  buffer_load_dwordx4 v9, s[44:47], s54 offen lds
  s_waitcnt vmcnt(8)
  s_mov_b64 exec, 1
  ds_add_u32 v124, v125 offset:1044
  s_mov_b64 exec, -1
  s_mov_b32 s60, 0
SPIN_223:
  ds_read_b32 v6, v124 offset:1068
  s_waitcnt lgkmcnt(0)
  v_readfirstlane_b32 s54, v6
  s_cmp_ge_u32 s54, 10
  s_cbranch_scc1 SPD_224
  s_add_u32 s60, s60, 1
  s_cmp_lt_u32 s60, 200000
  s_sleep 1
  s_cbranch_scc1 SPIN_223
  v_mov_b32 v6, 16
  ds_or_b32 v124, v6 offset:1024
SPD_224:
  v_add_u32 v29, 131072, v29
  ds_write_b128 v29, v[32:35] offset:0
  ds_write_b128 v29, v[36:39] offset:2048
  ds_write_b128 v29, v[40:43] offset:4096
  ds_write_b128 v29, v[44:47] offset:6144
  ds_write_b128 v29, v[48:51] offset:8192
  ds_write_b128 v29, v[52:55] offset:10240
  ds_write_b128 v29, v[56:59] offset:12288
  ds_write_b128 v29, v[60:63] offset:14336
  s_mov_b64 exec, 1
  ds_add_u32 v124, v125 offset:1052
  s_mov_b64 exec, -1
  s_waitcnt vmcnt(0)
  s_mov_b64 exec, 1
  ds_add_u32 v124, v125 offset:1048
  s_mov_b64 exec, -1
  s_mov_b32 s60, 0
SPIN_225:
  ds_read_b32 v6, v124 offset:1072
  s_waitcnt lgkmcnt(0)
  v_readfirstlane_b32 s54, v6
  s_cmp_ge_u32 s54, 10
  s_cbranch_scc1 SPD_226
  s_add_u32 s60, s60, 1
  s_cmp_lt_u32 s60, 200000
  s_sleep 1
  s_cbranch_scc1 SPIN_225
  v_mov_b32 v6, 16
  ds_or_b32 v124, v6 offset:1024
SPD_226:
  ds_write_b128 v29, v[64:67] offset:16384
  ds_write_b128 v29, v[68:71] offset:18432
  ds_write_b128 v29, v[72:75] offset:20480
  ds_write_b128 v29, v[76:79] offset:22528
  ds_write_b128 v29, v[80:83] offset:24576
  ds_write_b128 v29, v[84:87] offset:26624
  ds_write_b128 v29, v[88:91] offset:28672
  ds_write_b128 v29, v[92:95] offset:30720
  s_mov_b64 exec, 1
  ds_add_u32 v124, v125 offset:1056
  s_mov_b64 exec, -1
  s_cmp_eq_u32 s3, 10
  s_cbranch_scc0 W11_227
  s_setprio 3
  s_mov_b32 s60, 0
SPIN_228:
  ds_read_b32 v6, v124 offset:1104
  s_waitcnt lgkmcnt(0)
  v_readfirstlane_b32 s54, v6
  s_cmp_ge_u32 s54, 4
  s_cbranch_scc1 SPD_229
  s_add_u32 s60, s60, 1
  s_cmp_lt_u32 s60, 200000
  s_sleep 1
  s_cbranch_scc1 SPIN_228
  v_mov_b32 v6, 16
  ds_or_b32 v124, v6 offset:1024
SPD_229:
  s_mul_i32 s70, s52, 157
  s_sub_u32 s70, 10000, s70
  s_min_u32 s70, s70, 157
  v_mov_b32 v57, 0xf0000000
  v_add_u32 v30, 0, v1
  v_lshlrev_b32 v48, 2, v30
  ds_read_b32 v33, v48 offset:0
  v_add_u32 v31, 64, v1
  v_lshlrev_b32 v48, 2, v31
  ds_read_b32 v34, v48 offset:0
  v_add_u32 v32, 128, v1
  v_lshlrev_b32 v48, 2, v32
  ds_read_b32 v35, v48 offset:0
  v_lshlrev_b32 v51, 2, v1
  s_waitcnt lgkmcnt(0)
  v_min_u32 v36, 63, v33
  v_sub_u32 v36, 63, v36
  v_lshlrev_b32 v36, 2, v36
  ds_add_rtn_u32 v39, v36, v125 offset:768
  v_min_u32 v37, 63, v34
  v_sub_u32 v37, 63, v37
  v_lshlrev_b32 v37, 2, v37
  ds_add_rtn_u32 v40, v37, v125 offset:768
  s_mov_b32 exec_hi, 0
  v_min_u32 v38, 63, v35
  v_sub_u32 v38, 63, v38
  v_lshlrev_b32 v38, 2, v38
  ds_add_rtn_u32 v41, v38, v125 offset:768
  v_cmp_lt_u32 vcc, 63, v35
  s_mov_b64 exec, -1
  ds_read_b32 v49, v51 offset:768
  v_max_u32 v48, v33, v34
  v_cmp_lt_u32 s[56:57], 63, v48
  s_or_b64 vcc, vcc, s[56:57]
  s_cbranch_vccz S2A_230
  v_mov_b32 v48, 2
  ds_or_b32 v124, v48 offset:1024
S2A_230:
  s_waitcnt lgkmcnt(0)
  v_mov_b32 v50, v49
  s_nop 1
  v_add_u32_dpp v50, v50, v50 row_shr:1 row_mask:0xf bank_mask:0xf bound_ctrl:0
  s_nop 1
  v_add_u32_dpp v50, v50, v50 row_shr:2 row_mask:0xf bank_mask:0xf bound_ctrl:0
  s_nop 1
  v_add_u32_dpp v50, v50, v50 row_shr:4 row_mask:0xf bank_mask:0xf bound_ctrl:0
  s_nop 1
  v_add_u32_dpp v50, v50, v50 row_shr:8 row_mask:0xf bank_mask:0xf bound_ctrl:0
  s_nop 1
  v_add_u32_dpp v50, v50, v50 row_bcast:15 row_mask:0xa bank_mask:0xf
  s_nop 1
  v_add_u32_dpp v50, v50, v50 row_bcast:31 row_mask:0xc bank_mask:0xf
  s_nop 1
  v_sub_u32 v50, v50, v49
  ds_bpermute_b32 v42, v36, v50
  ds_bpermute_b32 v43, v37, v50
  ds_bpermute_b32 v44, v38, v50
  s_waitcnt lgkmcnt(0)
  v_add_u32 v42, v42, v39
  v_and_b32 v36, -4, v42
  ds_bpermute_b32 v45, v36, v24
  v_add_u32 v43, v43, v40
  v_and_b32 v37, -4, v43
  ds_bpermute_b32 v46, v37, v24
  v_add_u32 v44, v44, v41
  v_and_b32 v38, -4, v44
  ds_bpermute_b32 v47, v38, v24
  v_min_u32 v49, 63, v33
  ds_write_b8 v42, v49 offset:4352
  v_lshlrev_b32 v48, 3, v42
  v_lshlrev_b32 v52, 7, v30
  v_lshlrev_b32 v53, 9, v30
  v_cmp_gt_u32 vcc, s70, v30
  s_nop 1
  v_cndmask_b32 v53, v57, v53, vcc
  ds_write_b64 v48, v[52:53] offset:3072
  v_min_u32 v49, 63, v34
  ds_write_b8 v43, v49 offset:4352
  v_lshlrev_b32 v48, 3, v43
  v_lshlrev_b32 v52, 7, v31
  v_lshlrev_b32 v53, 9, v31
  v_cmp_gt_u32 vcc, s70, v31
  s_nop 1
  v_cndmask_b32 v53, v57, v53, vcc
  ds_write_b64 v48, v[52:53] offset:3072
  s_mov_b32 exec_hi, 0
  v_min_u32 v49, 63, v35
  ds_write_b8 v44, v49 offset:4352
  v_lshlrev_b32 v48, 3, v44
  v_lshlrev_b32 v52, 7, v32
  v_lshlrev_b32 v53, 9, v32
  v_cmp_gt_u32 vcc, s70, v32
  s_nop 1
  v_cndmask_b32 v53, v57, v53, vcc
  ds_write_b64 v48, v[52:53] offset:3072
  s_mov_b64 exec, -1
  v_min_u32 v54, 63, v33
  v_add_u32 v54, 1, v54
  v_lshrrev_b32 v54, 1, v54
  v_min_u32 v55, 63, v34
  v_add_u32 v55, 1, v55
  v_lshrrev_b32 v55, 1, v55
  v_min_u32 v56, 63, v35
  v_add_u32 v56, 1, v56
  v_lshrrev_b32 v56, 1, v56
  s_waitcnt lgkmcnt(0)
  v_and_b32 v48, 3, v42
  v_cmp_eq_u32 vcc, 0, v48
  v_lshrrev_b32 v49, 2, v42
  s_mov_b64 exec, vcc
  ds_write_b32 v45, v54 offset:4992
  ds_write_b32 v45, v49 offset:5248
  s_mov_b64 exec, -1
  v_and_b32 v48, 3, v43
  v_cmp_eq_u32 vcc, 0, v48
  v_lshrrev_b32 v49, 2, v43
  s_mov_b64 exec, vcc
  ds_write_b32 v46, v55 offset:4992
  ds_write_b32 v46, v49 offset:5248
  s_mov_b64 exec, -1
  v_and_b32 v48, 3, v44
  v_cmp_eq_u32 vcc, 0, v48
  s_mov_b32 vcc_hi, 0
  v_lshrrev_b32 v49, 2, v44
  s_mov_b64 exec, vcc
  ds_write_b32 v47, v56 offset:4992
  ds_write_b32 v47, v49 offset:5248
  s_mov_b64 exec, -1
  v_mov_b32 v49, 0
  s_mov_b32 exec_hi, 0xff
  ds_read_b32 v49, v51 offset:4992
  s_mov_b64 exec, -1
  s_waitcnt lgkmcnt(0)
  v_mov_b32 v50, v49
  s_nop 1
  v_add_u32_dpp v50, v50, v50 row_shr:1 row_mask:0xf bank_mask:0xf bound_ctrl:0
  s_nop 1
  v_add_u32_dpp v50, v50, v50 row_shr:2 row_mask:0xf bank_mask:0xf bound_ctrl:0
  s_nop 1
  v_add_u32_dpp v50, v50, v50 row_shr:4 row_mask:0xf bank_mask:0xf bound_ctrl:0
  s_nop 1
  v_add_u32_dpp v50, v50, v50 row_shr:8 row_mask:0xf bank_mask:0xf bound_ctrl:0
  s_nop 1
  v_add_u32_dpp v50, v50, v50 row_bcast:15 row_mask:0xa bank_mask:0xf
  s_nop 1
  v_add_u32_dpp v50, v50, v50 row_bcast:31 row_mask:0xc bank_mask:0xf
  s_nop 1
  v_readlane_b32 s54, v50, 63
  v_sub_u32 v50, v50, v49
  ds_bpermute_b32 v39, v45, v50
  ds_bpermute_b32 v36, v45, v49
  ds_bpermute_b32 v40, v46, v50
  ds_bpermute_b32 v37, v46, v49
  ds_bpermute_b32 v41, v47, v50
  ds_bpermute_b32 v38, v47, v49
  s_mov_b32 exec_hi, 0xff
  ds_write_b32 v51, v50 offset:4992
  s_mov_b64 exec, -1
  v_mov_b32 v48, s54
  ds_write_b32 v124, v48 offset:5504
  s_cmp_le_u32 s54, 504
  s_cbranch_scc1 S2B_231
  v_mov_b32 v48, 4
  ds_or_b32 v124, v48 offset:1024
S2B_231:
  s_waitcnt lgkmcnt(0)
  v_and_b32 v48, 3, v42
  v_lshlrev_b32 v52, 6, v39
  v_lshl_add_u32 v52, v48, 3, v52
  v_add_u32 v52, 98304, v52
  v_lshlrev_b32 v49, 2, v30
  ds_write_b32 v49, v52 offset:1536
  v_and_b32 v48, 3, v43
  v_lshlrev_b32 v52, 6, v40
  v_lshl_add_u32 v52, v48, 3, v52
  v_add_u32 v52, 98304, v52
  v_lshlrev_b32 v49, 2, v31
  ds_write_b32 v49, v52 offset:1536
  s_mov_b32 exec_hi, 0
  v_and_b32 v48, 3, v44
  v_lshlrev_b32 v52, 6, v41
  v_lshl_add_u32 v52, v48, 3, v52
  v_add_u32 v52, 98304, v52
  v_lshlrev_b32 v49, 2, v32
  ds_write_b32 v49, v52 offset:1536
  s_mov_b64 exec, -1
  v_add_u32 v49, 160, v1
  v_lshlrev_b32 v49, 2, v49
  v_mov_b32 v52, 0x00f00000
  s_mov_b32 exec_hi, 0
  ds_write_b32 v49, v52 offset:1536
  s_mov_b64 exec, -1
  s_waitcnt lgkmcnt(0)
  ds_read_b32 v6, v124 offset:1024
  s_waitcnt lgkmcnt(0)
  v_readfirstlane_b32 s54, v6
  s_cmp_eq_u32 s54, 0
  s_cselect_b32 s54, 1, 0x100
  v_mov_b32 v6, s54
  s_mov_b64 exec, 1
  ds_add_u32 v124, v6 offset:1108
  s_mov_b64 exec, -1
  s_cmp_eq_u32 s2, 0
  s_cbranch_scc0 NB0_232
  ds_read_b32 v6, v124 offset:1168
  s_waitcnt lgkmcnt(0)
  v_add_u32 v6, 1, v6
  s_mov_b64 exec, 1
  global_store_dword v124, v6, s[26:27] offset:0 sc1
  s_mov_b64 exec, -1
NB0_232:
  s_branch W1011_233
W11_227:
  s_mov_b32 s60, 0
SPIN_234:
  ds_read_b32 v6, v124 offset:1092
  s_waitcnt lgkmcnt(0)
  v_readfirstlane_b32 s54, v6
  s_cmp_ge_u32 s54, 10
  s_cbranch_scc1 SPD_235
  s_add_u32 s60, s60, 1
  s_cmp_lt_u32 s60, 200000
  s_sleep 1
  s_cbranch_scc1 SPIN_234
  v_mov_b32 v6, 16
  ds_or_b32 v124, v6 offset:1024
SPD_235:
  s_mul_i32 s54, s53, 2560000
  s_mul_i32 s55, s52, 40192
  s_add_u32 s54, s54, s55
  s_add_u32 s54, s54, 4096
  s_add_u32 s56, s26, s54
  s_addc_u32 s57, s27, 0
  s_sub_u32 s55, 2560000, s55
  s_min_u32 s55, s55, 40192
  s_mov_b32 s28, s56
  s_and_b32 s29, s57, 0xffff
  s_mov_b32 s30, s55
  s_mov_b32 s31, 0x00020000
  v_lshlrev_b32 v10, 7, v1
  s_mov_b32 s54, 0
  buffer_load_dword v100, v10, s[28:31], s54 offen sc1
  s_mov_b32 s54, 8192
  buffer_load_dword v101, v10, s[28:31], s54 offen sc1
  s_mov_b32 s54, 16384
  buffer_load_dword v102, v10, s[28:31], s54 offen sc1
  s_mov_b32 s54, 24576
  buffer_load_dword v103, v10, s[28:31], s54 offen sc1
  s_mov_b32 s54, 32768
  buffer_load_dword v104, v10, s[28:31], s54 offen sc1
  s_branch BMAIN_216
W1011_233:
  s_setprio 0
  s_branch BMAIN_216
W15_214:
  s_setprio 3
  s_add_u32 s56, s26, 11534336
  s_addc_u32 s57, s27, 0
  s_mov_b32 s40, s56
  s_and_b32 s41, s57, 0xffff
  s_mov_b32 s42, 2097152
  s_mov_b32 s43, 0x00020000
  s_add_u32 s56, s56, 2097152
  s_addc_u32 s57, s57, 0
  s_mov_b32 s44, s56
  s_and_b32 s45, s57, 0xffff
  s_mov_b32 s46, 2097152
  s_mov_b32 s47, 0x00020000
  s_mov_b32 s90, -1
  s_cmp_eq_u32 s63, 0
  s_cselect_b32 s91, -1, 0x1ffff
  s_mov_b32 s54, 6679
  s_waitcnt vmcnt(11)
  v_mul_u32_u24 v28, s54, v8
  v_lshrrev_b32 v28, 20, v28
  v_lshlrev_b32 v36, 2, v28
  ds_add_rtn_u32 v23, v36, v125 offset:1280
  v_mul_u32_u24 v29, s54, v9
  v_lshrrev_b32 v29, 20, v29
  v_lshlrev_b32 v37, 2, v29
  ds_add_rtn_u32 v24, v37, v125 offset:1280
  v_mul_u32_u24 v30, s54, v10
  v_lshrrev_b32 v30, 20, v30
  v_lshlrev_b32 v36, 2, v30
  ds_add_rtn_u32 v25, v36, v125 offset:1280
  v_mul_u32_u24 v31, s54, v11
  v_lshrrev_b32 v31, 20, v31
  v_lshlrev_b32 v37, 2, v31
  ds_add_rtn_u32 v26, v37, v125 offset:1280
  v_mul_u32_u24 v32, s54, v12
  v_lshrrev_b32 v32, 20, v32
  v_lshlrev_b32 v36, 2, v32
  s_mov_b64 exec, s[90:91]
  ds_add_rtn_u32 v27, v36, v125 offset:1280
  s_mov_b64 exec, -1
  s_movk_i32 s54, 157
  v_mul_u32_u24 v36, s54, v28
  v_sub_u32 v8, v8, v36
  v_mul_u32_u24 v36, s54, v29
  v_sub_u32 v9, v9, v36
  v_mul_u32_u24 v36, s54, v30
  v_sub_u32 v10, v10, v36
  v_mul_u32_u24 v36, s54, v31
  v_sub_u32 v11, v11, v36
  v_mul_u32_u24 v36, s54, v32
  v_sub_u32 v12, v12, v36
  s_waitcnt vmcnt(1) lgkmcnt(0)
  v_lshl_or_b32 v44, v13, 8, v8
  v_lshlrev_b32 v45, 16, v18
  v_lshl_or_b32 v46, v14, 8, v9
  v_lshlrev_b32 v47, 16, v19
  v_lshl_or_b32 v48, v15, 8, v10
  v_lshlrev_b32 v49, 16, v20
  v_lshl_or_b32 v50, v16, 8, v11
  v_lshlrev_b32 v51, 16, v21
  v_lshl_or_b32 v52, v17, 8, v12
  v_lshlrev_b32 v53, 16, v22
  v_max3_u32 v42, v23, v24, v25
  v_max_u32 v42, v42, v26
  v_lshlrev_b32 v36, 7, v28
  v_lshl_add_u32 v36, v23, 3, v36
  v_cmp_gt_u32 vcc, 15, v23
  s_mov_b64 exec, vcc
  ds_write_b64 v36, v[44:45] offset:1536
  s_mov_b64 exec, -1
  v_lshlrev_b32 v36, 7, v29
  v_lshl_add_u32 v36, v24, 3, v36
  v_cmp_gt_u32 vcc, 15, v24
  s_mov_b64 exec, vcc
  ds_write_b64 v36, v[46:47] offset:1536
  s_mov_b64 exec, -1
  v_lshlrev_b32 v36, 7, v30
  v_lshl_add_u32 v36, v25, 3, v36
  v_cmp_gt_u32 vcc, 15, v25
  s_mov_b64 exec, vcc
  ds_write_b64 v36, v[48:49] offset:1536
  s_mov_b64 exec, -1
  v_lshlrev_b32 v36, 7, v31
  v_lshl_add_u32 v36, v26, 3, v36
  v_cmp_gt_u32 vcc, 15, v26
  s_mov_b64 exec, vcc
  ds_write_b64 v36, v[50:51] offset:1536
  s_mov_b64 exec, -1
  v_lshlrev_b32 v36, 7, v32
  v_lshl_add_u32 v36, v27, 3, v36
  s_mov_b64 exec, s[90:91]
  v_max_u32 v42, v42, v27
  v_cmp_gt_u32 vcc, 15, v27
  s_and_b64 exec, exec, vcc
  ds_write_b64 v36, v[52:53] offset:1536
  s_mov_b64 exec, -1
  s_mov_b64 exec, 1
  ds_add_u32 v124, v125 offset:1112
  s_mov_b64 exec, -1
  s_waitcnt vmcnt(0)
  s_cmp_eq_u32 s63, 0
  s_cbranch_scc1 T14_236
  ds_write_b32 v124, v40 offset:1168
  v_add_u32 v41, 0x5b, v40
  v_lshlrev_b32 v41, 24, v41
  s_mov_b32 s54, 0x9E3779B1
  v_mul_lo_u32 v40, s54, v40
  v_add_u32 v40, 0x7F4A7C15, v40
  v_lshrrev_b32 v40, 8, v40
  v_or_b32 v40, v40, v41
  ds_write_b32 v124, v40 offset:1120
  s_mov_b64 exec, 1
  ds_add_u32 v124, v125 offset:1116
  s_mov_b64 exec, -1
  s_branch TD_237
T14_236:
  s_mov_b32 s60, 0
SPIN_238:
  ds_read_b32 v36, v124 offset:1116
  s_waitcnt lgkmcnt(0)
  v_readfirstlane_b32 s54, v36
  s_cmp_ge_u32 s54, 1
  s_cbranch_scc1 SPD_239
  s_add_u32 s60, s60, 1
  s_cmp_lt_u32 s60, 200000
  s_sleep 1
  s_cbranch_scc1 SPIN_238
  v_mov_b32 v36, 16
  ds_or_b32 v124, v36 offset:1024
SPD_239:
  ds_read_b32 v40, v124 offset:1120
  s_waitcnt lgkmcnt(0)
TD_237:
  v_and_b32 v41, 0xff000000, v40
  v_cmp_le_u32 vcc, 15, v42
  s_cbranch_vccz NOV_240
  s_lshl_b32 s54, s2, 7
  v_subrev_u32 v36, 15, v23
  v_cmp_gt_u32 vcc, 16, v36
  s_cbranch_vccz OVS_241
  v_lshlrev_b32 v37, 15, v28
  v_lshl_add_u32 v37, v36, 3, v37
  v_or_b32 v44, v44, v41
  s_mov_b64 exec, vcc
  buffer_store_dwordx2 v[44:45], v37, s[44:47], s54 offen sc1
OVS_241:
  s_mov_b64 exec, -1
  v_subrev_u32 v36, 15, v24
  v_cmp_gt_u32 vcc, 16, v36
  s_cbranch_vccz OVS_242
  v_lshlrev_b32 v37, 15, v29
  v_lshl_add_u32 v37, v36, 3, v37
  v_or_b32 v46, v46, v41
  s_mov_b64 exec, vcc
  buffer_store_dwordx2 v[46:47], v37, s[44:47], s54 offen sc1
OVS_242:
  s_mov_b64 exec, -1
  v_subrev_u32 v36, 15, v25
  v_cmp_gt_u32 vcc, 16, v36
  s_cbranch_vccz OVS_243
  v_lshlrev_b32 v37, 15, v30
  v_lshl_add_u32 v37, v36, 3, v37
  v_or_b32 v48, v48, v41
  s_mov_b64 exec, vcc
  buffer_store_dwordx2 v[48:49], v37, s[44:47], s54 offen sc1
OVS_243:
  s_mov_b64 exec, -1
  v_subrev_u32 v36, 15, v26
  v_cmp_gt_u32 vcc, 16, v36
  s_cbranch_vccz OVS_244
  v_lshlrev_b32 v37, 15, v31
  v_lshl_add_u32 v37, v36, 3, v37
  v_or_b32 v50, v50, v41
  s_mov_b64 exec, vcc
  buffer_store_dwordx2 v[50:51], v37, s[44:47], s54 offen sc1
OVS_244:
  s_mov_b64 exec, -1
  v_subrev_u32 v36, 15, v27
  s_mov_b64 exec, s[90:91]
  v_cmp_gt_u32 vcc, 16, v36
  s_cbranch_vccz OVS_245
  v_lshlrev_b32 v37, 15, v32
  v_lshl_add_u32 v37, v36, 3, v37
  v_or_b32 v52, v52, v41
  s_mov_b64 exec, vcc
  buffer_store_dwordx2 v[52:53], v37, s[44:47], s54 offen sc1
OVS_245:
  s_mov_b64 exec, -1
NOV_240:
  s_mov_b32 s60, 0
SPIN_246:
  ds_read_b32 v36, v124 offset:1112
  s_waitcnt lgkmcnt(0)
  v_readfirstlane_b32 s54, v36
  s_cmp_ge_u32 s54, 2
  s_cbranch_scc1 SPD_247
  s_add_u32 s60, s60, 1
  s_cmp_lt_u32 s60, 200000
  s_sleep 1
  s_cbranch_scc1 SPIN_246
  v_mov_b32 v36, 16
  ds_or_b32 v124, v36 offset:1024
SPD_247:
  v_lshlrev_b32 v36, 4, v1
  s_lshl_b32 s54, s63, 12
  v_add_u32 v36, s54, v36
  v_lshrrev_b32 v38, 3, v1
  s_lshl_b32 s54, s63, 7
  v_lshl_add_u32 v37, v38, 2, s54
  ds_read_b128 v[48:51], v36 offset:1536
  ds_read_b32 v8, v37 offset:1280
  ds_read_b128 v[52:55], v36 offset:2560
  ds_read_b32 v9, v37 offset:1312
  ds_read_b128 v[56:59], v36 offset:3584
  ds_read_b32 v10, v37 offset:1344
  ds_read_b128 v[60:63], v36 offset:4608
  ds_read_b32 v11, v37 offset:1376
  v_lshlrev_b32 v38, 15, v38
  v_and_b32 v39, 7, v1
  v_lshl_add_u32 v38, v39, 4, v38
  v_cmp_eq_u32 vcc, 7, v39
  s_lshl_b32 s55, s2, 7
  s_lshl_b32 s56, s63, 20
  s_add_u32 s55, s55, s56
  s_waitcnt lgkmcnt(6)
  v_min_u32 v8, 255, v8
  v_cndmask_b32 v50, v50, v8, vcc
  v_cndmask_b32 v51, v51, v40, vcc
  v_or_b32 v48, v48, v41
  v_or_b32 v50, v50, v41
  s_add_u32 s54, s55, 0
  buffer_store_dwordx4 v[48:51], v38, s[40:43], s54 offen sc1
  s_waitcnt lgkmcnt(4)
  v_min_u32 v9, 255, v9
  v_cndmask_b32 v54, v54, v9, vcc
  v_cndmask_b32 v55, v55, v40, vcc
  v_or_b32 v52, v52, v41
  v_or_b32 v54, v54, v41
  s_add_u32 s54, s55, 262144
  buffer_store_dwordx4 v[52:55], v38, s[40:43], s54 offen sc1
  s_waitcnt lgkmcnt(2)
  v_min_u32 v10, 255, v10
  v_cndmask_b32 v58, v58, v10, vcc
  v_cndmask_b32 v59, v59, v40, vcc
  v_or_b32 v56, v56, v41
  v_or_b32 v58, v58, v41
  s_add_u32 s54, s55, 524288
  buffer_store_dwordx4 v[56:59], v38, s[40:43], s54 offen sc1
  s_waitcnt lgkmcnt(0)
  v_min_u32 v11, 255, v11
  v_cndmask_b32 v62, v62, v11, vcc
  v_cndmask_b32 v63, v63, v40, vcc
  v_or_b32 v60, v60, v41
  v_or_b32 v62, v62, v41
  s_add_u32 s54, s55, 786432
  buffer_store_dwordx4 v[60:63], v38, s[40:43], s54 offen sc1
REC_215:
  s_setprio 2
  s_mov_b32 s60, 0
SPIN_248:
  ds_read_b32 v6, v124 offset:1116
  s_waitcnt lgkmcnt(0)
  v_readfirstlane_b32 s54, v6
  s_cmp_ge_u32 s54, 1
  s_cbranch_scc1 SPD_249
  s_add_u32 s60, s60, 1
  s_cmp_lt_u32 s60, 200000
  s_sleep 1
  s_cbranch_scc1 SPIN_248
  v_mov_b32 v6, 16
  ds_or_b32 v124, v6 offset:1024
SPD_249:
  ds_read_b32 v112, v124 offset:1120
  s_lshl_b32 s54, s52, 15
  s_add_u32 s54, s54, 11534336
  s_add_u32 s56, s26, s54
  s_addc_u32 s57, s27, 0
  s_mov_b32 s32, s56
  s_and_b32 s33, s57, 0xffff
  s_mov_b32 s34, 32768
  s_mov_b32 s35, 0x00020000
  s_add_u32 s56, s56, 2097152
  s_addc_u32 s57, s57, 0
  s_mov_b32 s36, s56
  s_and_b32 s37, s57, 0xffff
  s_mov_b32 s38, 32768
  s_mov_b32 s39, 0x00020000
  s_sub_u32 s61, s3, 12
  s_lshl_b32 s61, s61, 10
  v_lshlrev_b32 v7, 4, v1
  v_and_b32 v4, 7, v1
  v_lshlrev_b32 v4, 1, v4
  s_mov_b32 s62, 0
  s_waitcnt lgkmcnt(0)
  v_lshrrev_b32 v113, 24, v112
  s_mov_b32 s63, 0
  s_mov_b32 s88, 0x80808080
  s_mov_b32 s89, 0x80808080
  s_mov_b64 s[64:65], -1
  s_mov_b64 s[66:67], -1
  s_mov_b64 s[68:69], -1
  s_mov_b64 s[70:71], -1
  s_mov_b64 s[72:73], -1
  s_mov_b64 s[74:75], -1
  s_mov_b64 s[76:77], -1
  s_mov_b64 s[78:79], -1
  s_cmp_lt_u32 s3, 14
  s_cbranch_scc1 NOPROBE_255
  s_add_u32 s54, s61, 28672
PROBE_253:
  buffer_load_dwordx4 v[36:39], v7, s[32:35], s54 offen sc1
  s_waitcnt vmcnt(0)
  v_cmp_ne_u32 vcc, v112, v39
  s_and_b64 vcc, vcc, s[88:89]
  s_cbranch_vccz PROBED_254
  s_add_u32 s63, s63, 1
  s_cmp_lt_u32 s63, 20000
  s_sleep 8
  s_cbranch_scc1 PROBE_253
  v_mov_b32 v6, 16
  ds_or_b32 v124, v6 offset:1024
PROBED_254:
  s_mov_b64 s[78:79], 0
  s_mov_b32 s63, 0
NOPROBE_255:
RETRY_250:
  s_mov_b64 exec, s[64:65]
  s_cbranch_execz RSK_256
  s_add_u32 s54, s61, 0
  buffer_load_dwordx4 v[8:11], v7, s[32:35], s54 offen sc1
RSK_256:
  s_mov_b64 exec, s[66:67]
  s_cbranch_execz RSK_257
  s_add_u32 s54, s61, 4096
  buffer_load_dwordx4 v[12:15], v7, s[32:35], s54 offen sc1
RSK_257:
  s_mov_b64 exec, s[68:69]
  s_cbranch_execz RSK_258
  s_add_u32 s54, s61, 8192
  buffer_load_dwordx4 v[16:19], v7, s[32:35], s54 offen sc1
RSK_258:
  s_mov_b64 exec, s[70:71]
  s_cbranch_execz RSK_259
  s_add_u32 s54, s61, 12288
  buffer_load_dwordx4 v[20:23], v7, s[32:35], s54 offen sc1
RSK_259:
  s_mov_b64 exec, s[72:73]
  s_cbranch_execz RSK_260
  s_add_u32 s54, s61, 16384
  buffer_load_dwordx4 v[24:27], v7, s[32:35], s54 offen sc1
RSK_260:
  s_mov_b64 exec, s[74:75]
  s_cbranch_execz RSK_261
  s_add_u32 s54, s61, 20480
  buffer_load_dwordx4 v[28:31], v7, s[32:35], s54 offen sc1
RSK_261:
  s_mov_b64 exec, s[76:77]
  s_cbranch_execz RSK_262
  s_add_u32 s54, s61, 24576
  buffer_load_dwordx4 v[32:35], v7, s[32:35], s54 offen sc1
RSK_262:
  s_mov_b64 exec, s[78:79]
  s_cbranch_execz RSK_263
  s_add_u32 s54, s61, 28672
  buffer_load_dwordx4 v[36:39], v7, s[32:35], s54 offen sc1
RSK_263:
  s_mov_b64 exec, -1
  s_mov_b64 s[58:59], 0
  s_waitcnt vmcnt(0)
  v_cmp_ne_u32 vcc, v112, v11
  s_and_b64 vcc, vcc, s[88:89]
  s_or_b64 s[58:59], s[58:59], vcc
  s_lshr_b64 vcc, vcc, 7
  s_lshl_b64 s[64:65], vcc, 8
  s_sub_u32 s64, s64, vcc_lo
  s_subb_u32 s65, s65, vcc_hi
  v_cmp_ne_u32 vcc, v112, v15
  s_and_b64 vcc, vcc, s[88:89]
  s_or_b64 s[58:59], s[58:59], vcc
  s_lshr_b64 vcc, vcc, 7
  s_lshl_b64 s[66:67], vcc, 8
  s_sub_u32 s66, s66, vcc_lo
  s_subb_u32 s67, s67, vcc_hi
  v_cmp_ne_u32 vcc, v112, v19
  s_and_b64 vcc, vcc, s[88:89]
  s_or_b64 s[58:59], s[58:59], vcc
  s_lshr_b64 vcc, vcc, 7
  s_lshl_b64 s[68:69], vcc, 8
  s_sub_u32 s68, s68, vcc_lo
  s_subb_u32 s69, s69, vcc_hi
  v_cmp_ne_u32 vcc, v112, v23
  s_and_b64 vcc, vcc, s[88:89]
  s_or_b64 s[58:59], s[58:59], vcc
  s_lshr_b64 vcc, vcc, 7
  s_lshl_b64 s[70:71], vcc, 8
  s_sub_u32 s70, s70, vcc_lo
  s_subb_u32 s71, s71, vcc_hi
  v_cmp_ne_u32 vcc, v112, v27
  s_and_b64 vcc, vcc, s[88:89]
  s_or_b64 s[58:59], s[58:59], vcc
  s_lshr_b64 vcc, vcc, 7
  s_lshl_b64 s[72:73], vcc, 8
  s_sub_u32 s72, s72, vcc_lo
  s_subb_u32 s73, s73, vcc_hi
  v_cmp_ne_u32 vcc, v112, v31
  s_and_b64 vcc, vcc, s[88:89]
  s_or_b64 s[58:59], s[58:59], vcc
  s_lshr_b64 vcc, vcc, 7
  s_lshl_b64 s[74:75], vcc, 8
  s_sub_u32 s74, s74, vcc_lo
  s_subb_u32 s75, s75, vcc_hi
  v_cmp_ne_u32 vcc, v112, v35
  s_and_b64 vcc, vcc, s[88:89]
  s_or_b64 s[58:59], s[58:59], vcc
  s_lshr_b64 vcc, vcc, 7
  s_lshl_b64 s[76:77], vcc, 8
  s_sub_u32 s76, s76, vcc_lo
  s_subb_u32 s77, s77, vcc_hi
  v_cmp_ne_u32 vcc, v112, v39
  s_and_b64 vcc, vcc, s[88:89]
  s_or_b64 s[58:59], s[58:59], vcc
  s_lshr_b64 vcc, vcc, 7
  s_lshl_b64 s[78:79], vcc, 8
  s_sub_u32 s78, s78, vcc_lo
  s_subb_u32 s79, s79, vcc_hi
  s_cmp_eq_u64 s[58:59], 0
  s_cbranch_scc0 AGAIN_252
  v_and_b32 v5, 0xff, v10
  v_cmp_lt_u32 vcc, 15, v5
  s_and_b64 vcc, vcc, s[88:89]
  s_cbranch_vccz EB_264
  s_lshr_b64 vcc, vcc, 7
  s_lshl_b64 s[56:57], vcc, 8
  s_sub_u32 s56, s56, vcc_lo
  s_subb_u32 s57, s57, vcc_hi
  s_add_u32 s54, s61, 0
  s_mov_b64 exec, s[56:57]
  buffer_load_dwordx4 v[56:59], v7, s[36:39], s54 offen sc1
  s_mov_b64 exec, -1
EB_264:
  v_and_b32 v5, 0xff, v14
  v_cmp_lt_u32 vcc, 15, v5
  s_and_b64 vcc, vcc, s[88:89]
  s_cbranch_vccz EB_265
  s_lshr_b64 vcc, vcc, 7
  s_lshl_b64 s[56:57], vcc, 8
  s_sub_u32 s56, s56, vcc_lo
  s_subb_u32 s57, s57, vcc_hi
  s_add_u32 s54, s61, 4096
  s_mov_b64 exec, s[56:57]
  buffer_load_dwordx4 v[60:63], v7, s[36:39], s54 offen sc1
  s_mov_b64 exec, -1
EB_265:
  v_and_b32 v5, 0xff, v18
  v_cmp_lt_u32 vcc, 15, v5
  s_and_b64 vcc, vcc, s[88:89]
  s_cbranch_vccz EB_266
  s_lshr_b64 vcc, vcc, 7
  s_lshl_b64 s[56:57], vcc, 8
  s_sub_u32 s56, s56, vcc_lo
  s_subb_u32 s57, s57, vcc_hi
  s_add_u32 s54, s61, 8192
  s_mov_b64 exec, s[56:57]
  buffer_load_dwordx4 v[64:67], v7, s[36:39], s54 offen sc1
  s_mov_b64 exec, -1
EB_266:
  v_and_b32 v5, 0xff, v22
  v_cmp_lt_u32 vcc, 15, v5
  s_and_b64 vcc, vcc, s[88:89]
  s_cbranch_vccz EB_267
  s_lshr_b64 vcc, vcc, 7
  s_lshl_b64 s[56:57], vcc, 8
  s_sub_u32 s56, s56, vcc_lo
  s_subb_u32 s57, s57, vcc_hi
  s_add_u32 s54, s61, 12288
  s_mov_b64 exec, s[56:57]
  buffer_load_dwordx4 v[68:71], v7, s[36:39], s54 offen sc1
  s_mov_b64 exec, -1
EB_267:
  v_and_b32 v5, 0xff, v26
  v_cmp_lt_u32 vcc, 15, v5
  s_and_b64 vcc, vcc, s[88:89]
  s_cbranch_vccz EB_268
  s_lshr_b64 vcc, vcc, 7
  s_lshl_b64 s[56:57], vcc, 8
  s_sub_u32 s56, s56, vcc_lo
  s_subb_u32 s57, s57, vcc_hi
  s_add_u32 s54, s61, 16384
  s_mov_b64 exec, s[56:57]
  buffer_load_dwordx4 v[72:75], v7, s[36:39], s54 offen sc1
  s_mov_b64 exec, -1
EB_268:
  v_and_b32 v5, 0xff, v30
  v_cmp_lt_u32 vcc, 15, v5
  s_and_b64 vcc, vcc, s[88:89]
  s_cbranch_vccz EB_269
  s_lshr_b64 vcc, vcc, 7
  s_lshl_b64 s[56:57], vcc, 8
  s_sub_u32 s56, s56, vcc_lo
  s_subb_u32 s57, s57, vcc_hi
  s_add_u32 s54, s61, 20480
  s_mov_b64 exec, s[56:57]
  buffer_load_dwordx4 v[76:79], v7, s[36:39], s54 offen sc1
  s_mov_b64 exec, -1
EB_269:
  v_and_b32 v5, 0xff, v34
  v_cmp_lt_u32 vcc, 15, v5
  s_and_b64 vcc, vcc, s[88:89]
  s_cbranch_vccz EB_270
  s_lshr_b64 vcc, vcc, 7
  s_lshl_b64 s[56:57], vcc, 8
  s_sub_u32 s56, s56, vcc_lo
  s_subb_u32 s57, s57, vcc_hi
  s_add_u32 s54, s61, 24576
  s_mov_b64 exec, s[56:57]
  buffer_load_dwordx4 v[80:83], v7, s[36:39], s54 offen sc1
  s_mov_b64 exec, -1
EB_270:
  v_and_b32 v5, 0xff, v38
  v_cmp_lt_u32 vcc, 15, v5
  s_and_b64 vcc, vcc, s[88:89]
  s_cbranch_vccz EB_271
  s_lshr_b64 vcc, vcc, 7
  s_lshl_b64 s[56:57], vcc, 8
  s_sub_u32 s56, s56, vcc_lo
  s_subb_u32 s57, s57, vcc_hi
  s_add_u32 s54, s61, 28672
  s_mov_b64 exec, s[56:57]
  buffer_load_dwordx4 v[84:87], v7, s[36:39], s54 offen sc1
  s_mov_b64 exec, -1
EB_271:
  v_cmp_ne_u32_sdwa vcc, v8, v113 src0_sel:BYTE_3 src1_sel:DWORD
  s_or_b64 s[58:59], s[58:59], vcc
  v_cmp_ne_u32_sdwa vcc, v10, v113 src0_sel:BYTE_3 src1_sel:DWORD
  s_or_b64 s[58:59], s[58:59], vcc
  v_cmp_ne_u32_sdwa vcc, v12, v113 src0_sel:BYTE_3 src1_sel:DWORD
  s_or_b64 s[58:59], s[58:59], vcc
  v_cmp_ne_u32_sdwa vcc, v14, v113 src0_sel:BYTE_3 src1_sel:DWORD
  s_or_b64 s[58:59], s[58:59], vcc
  v_cmp_ne_u32_sdwa vcc, v16, v113 src0_sel:BYTE_3 src1_sel:DWORD
  s_or_b64 s[58:59], s[58:59], vcc
  v_cmp_ne_u32_sdwa vcc, v18, v113 src0_sel:BYTE_3 src1_sel:DWORD
  s_or_b64 s[58:59], s[58:59], vcc
  v_cmp_ne_u32_sdwa vcc, v20, v113 src0_sel:BYTE_3 src1_sel:DWORD
  s_or_b64 s[58:59], s[58:59], vcc
  v_cmp_ne_u32_sdwa vcc, v22, v113 src0_sel:BYTE_3 src1_sel:DWORD
  s_or_b64 s[58:59], s[58:59], vcc
  v_cmp_ne_u32_sdwa vcc, v24, v113 src0_sel:BYTE_3 src1_sel:DWORD
  s_or_b64 s[58:59], s[58:59], vcc
  v_cmp_ne_u32_sdwa vcc, v26, v113 src0_sel:BYTE_3 src1_sel:DWORD
  s_or_b64 s[58:59], s[58:59], vcc
  v_cmp_ne_u32_sdwa vcc, v28, v113 src0_sel:BYTE_3 src1_sel:DWORD
  s_or_b64 s[58:59], s[58:59], vcc
  v_cmp_ne_u32_sdwa vcc, v30, v113 src0_sel:BYTE_3 src1_sel:DWORD
  s_or_b64 s[58:59], s[58:59], vcc
  v_cmp_ne_u32_sdwa vcc, v32, v113 src0_sel:BYTE_3 src1_sel:DWORD
  s_or_b64 s[58:59], s[58:59], vcc
  v_cmp_ne_u32_sdwa vcc, v34, v113 src0_sel:BYTE_3 src1_sel:DWORD
  s_or_b64 s[58:59], s[58:59], vcc
  v_cmp_ne_u32_sdwa vcc, v36, v113 src0_sel:BYTE_3 src1_sel:DWORD
  s_or_b64 s[58:59], s[58:59], vcc
  v_cmp_ne_u32_sdwa vcc, v38, v113 src0_sel:BYTE_3 src1_sel:DWORD
  s_or_b64 s[58:59], s[58:59], vcc
  s_cmp_eq_u64 s[58:59], 0
  s_cbranch_scc1 OKA_251
  s_mov_b64 s[64:65], -1
  s_mov_b64 s[66:67], -1
  s_mov_b64 s[68:69], -1
  s_mov_b64 s[70:71], -1
  s_mov_b64 s[72:73], -1
  s_mov_b64 s[74:75], -1
  s_mov_b64 s[76:77], -1
  s_mov_b64 s[78:79], -1
AGAIN_252:
  s_add_u32 s63, s63, 1
  s_cmp_lt_u32 s63, 20000
  s_sleep 4
  s_cbranch_scc1 RETRY_250
  v_mov_b32 v6, 16
  ds_or_b32 v124, v6 offset:1024
OKA_251:
  ds_swizzle_b32 v104, v10 offset:0x00f8
  ds_swizzle_b32 v105, v14 offset:0x00f8
  ds_swizzle_b32 v106, v18 offset:0x00f8
  ds_swizzle_b32 v107, v22 offset:0x00f8
  ds_swizzle_b32 v108, v26 offset:0x00f8
  ds_swizzle_b32 v109, v30 offset:0x00f8
  ds_swizzle_b32 v110, v34 offset:0x00f8
  ds_swizzle_b32 v111, v38 offset:0x00f8
  v_lshlrev_b32_sdwa v114, 2, v8 dst_sel:DWORD dst_unused:UNUSED_PAD src0_sel:DWORD src1_sel:BYTE_0
  ds_add_u32 v114, v125 offset:0
  v_lshlrev_b32_sdwa v115, 2, v12 dst_sel:DWORD dst_unused:UNUSED_PAD src0_sel:DWORD src1_sel:BYTE_0
  ds_add_u32 v115, v125 offset:0
  v_lshlrev_b32_sdwa v114, 2, v16 dst_sel:DWORD dst_unused:UNUSED_PAD src0_sel:DWORD src1_sel:BYTE_0
  ds_add_u32 v114, v125 offset:0
  v_lshlrev_b32_sdwa v115, 2, v20 dst_sel:DWORD dst_unused:UNUSED_PAD src0_sel:DWORD src1_sel:BYTE_0
  ds_add_u32 v115, v125 offset:0
  v_lshlrev_b32_sdwa v114, 2, v24 dst_sel:DWORD dst_unused:UNUSED_PAD src0_sel:DWORD src1_sel:BYTE_0
  ds_add_u32 v114, v125 offset:0
  v_lshlrev_b32_sdwa v115, 2, v28 dst_sel:DWORD dst_unused:UNUSED_PAD src0_sel:DWORD src1_sel:BYTE_0
  ds_add_u32 v115, v125 offset:0
  v_lshlrev_b32_sdwa v114, 2, v32 dst_sel:DWORD dst_unused:UNUSED_PAD src0_sel:DWORD src1_sel:BYTE_0
  ds_add_u32 v114, v125 offset:0
  v_lshlrev_b32_sdwa v115, 2, v36 dst_sel:DWORD dst_unused:UNUSED_PAD src0_sel:DWORD src1_sel:BYTE_0
  ds_add_u32 v115, v125 offset:0
  s_not_b64 s[56:57], s[88:89]
  s_mov_b64 exec, s[56:57]
  v_lshlrev_b32_sdwa v114, 2, v10 dst_sel:DWORD dst_unused:UNUSED_PAD src0_sel:DWORD src1_sel:BYTE_0
  ds_add_u32 v114, v125 offset:0
  v_lshlrev_b32_sdwa v115, 2, v14 dst_sel:DWORD dst_unused:UNUSED_PAD src0_sel:DWORD src1_sel:BYTE_0
  ds_add_u32 v115, v125 offset:0
  v_lshlrev_b32_sdwa v114, 2, v18 dst_sel:DWORD dst_unused:UNUSED_PAD src0_sel:DWORD src1_sel:BYTE_0
  ds_add_u32 v114, v125 offset:0
  v_lshlrev_b32_sdwa v115, 2, v22 dst_sel:DWORD dst_unused:UNUSED_PAD src0_sel:DWORD src1_sel:BYTE_0
  ds_add_u32 v115, v125 offset:0
  v_lshlrev_b32_sdwa v114, 2, v26 dst_sel:DWORD dst_unused:UNUSED_PAD src0_sel:DWORD src1_sel:BYTE_0
  ds_add_u32 v114, v125 offset:0
  v_lshlrev_b32_sdwa v115, 2, v30 dst_sel:DWORD dst_unused:UNUSED_PAD src0_sel:DWORD src1_sel:BYTE_0
  ds_add_u32 v115, v125 offset:0
  v_lshlrev_b32_sdwa v114, 2, v34 dst_sel:DWORD dst_unused:UNUSED_PAD src0_sel:DWORD src1_sel:BYTE_0
  ds_add_u32 v114, v125 offset:0
  v_lshlrev_b32_sdwa v115, 2, v38 dst_sel:DWORD dst_unused:UNUSED_PAD src0_sel:DWORD src1_sel:BYTE_0
  ds_add_u32 v115, v125 offset:0
  s_mov_b64 exec, -1
  s_waitcnt lgkmcnt(8)
  v_and_b32 v104, 0xff, v104
  v_and_b32 v105, 0xff, v105
  v_and_b32 v106, 0xff, v106
  v_and_b32 v107, 0xff, v107
  v_and_b32 v108, 0xff, v108
  v_and_b32 v109, 0xff, v109
  v_and_b32 v110, 0xff, v110
  v_and_b32 v111, 0xff, v111
  v_max3_u32 v5, v104, v105, v106
  v_max3_u32 v5, v5, v107, v108
  v_max3_u32 v5, v5, v109, v110
  v_max_u32 v5, v5, v111
  v_cmp_lt_u32 vcc, 31, v5
  s_cbranch_vccz NOF_272
  v_mov_b32 v5, 1
  ds_or_b32 v124, v5 offset:1024
NOF_272:
  v_cmp_lt_u32 vcc, 15, v5
  s_cbranch_vccz NH2_273
  s_mov_b32 s62, 1
  s_mov_b32 s63, 0
  s_branch RETB2_276
RETB_274:
  v_cmp_lt_u32 vcc, 15, v104
  s_cbranch_vccz SK2_277
  s_add_u32 s54, s61, 0
  s_mov_b64 exec, vcc
  buffer_load_dwordx4 v[56:59], v7, s[36:39], s54 offen sc1
  s_mov_b64 exec, -1
SK2_277:
  v_cmp_lt_u32 vcc, 15, v105
  s_cbranch_vccz SK2_278
  s_add_u32 s54, s61, 4096
  s_mov_b64 exec, vcc
  buffer_load_dwordx4 v[60:63], v7, s[36:39], s54 offen sc1
  s_mov_b64 exec, -1
SK2_278:
  v_cmp_lt_u32 vcc, 15, v106
  s_cbranch_vccz SK2_279
  s_add_u32 s54, s61, 8192
  s_mov_b64 exec, vcc
  buffer_load_dwordx4 v[64:67], v7, s[36:39], s54 offen sc1
  s_mov_b64 exec, -1
SK2_279:
  v_cmp_lt_u32 vcc, 15, v107
  s_cbranch_vccz SK2_280
  s_add_u32 s54, s61, 12288
  s_mov_b64 exec, vcc
  buffer_load_dwordx4 v[68:71], v7, s[36:39], s54 offen sc1
  s_mov_b64 exec, -1
SK2_280:
  v_cmp_lt_u32 vcc, 15, v108
  s_cbranch_vccz SK2_281
  s_add_u32 s54, s61, 16384
  s_mov_b64 exec, vcc
  buffer_load_dwordx4 v[72:75], v7, s[36:39], s54 offen sc1
  s_mov_b64 exec, -1
SK2_281:
  v_cmp_lt_u32 vcc, 15, v109
  s_cbranch_vccz SK2_282
  s_add_u32 s54, s61, 20480
  s_mov_b64 exec, vcc
  buffer_load_dwordx4 v[76:79], v7, s[36:39], s54 offen sc1
  s_mov_b64 exec, -1
SK2_282:
  v_cmp_lt_u32 vcc, 15, v110
  s_cbranch_vccz SK2_283
  s_add_u32 s54, s61, 24576
  s_mov_b64 exec, vcc
  buffer_load_dwordx4 v[80:83], v7, s[36:39], s54 offen sc1
  s_mov_b64 exec, -1
SK2_283:
  v_cmp_lt_u32 vcc, 15, v111
  s_cbranch_vccz SK2_284
  s_add_u32 s54, s61, 28672
  s_mov_b64 exec, vcc
  buffer_load_dwordx4 v[84:87], v7, s[36:39], s54 offen sc1
  s_mov_b64 exec, -1
SK2_284:
RETB2_276:
  s_waitcnt vmcnt(0)
  s_mov_b64 s[58:59], 0
  v_cmp_lt_u32 vcc, 15, v104
  s_cbranch_vccz BV_285
  v_add_u32 v6, 15, v4
  v_cmp_gt_u32 vcc, v104, v6
  s_mov_b64 s[56:57], vcc
  v_cmp_ne_u32_sdwa vcc, v56, v113 src0_sel:BYTE_3 src1_sel:DWORD
  s_and_b64 vcc, vcc, s[56:57]
  s_or_b64 s[58:59], s[58:59], vcc
  v_add_u32 v6, 16, v4
  v_cmp_gt_u32 vcc, v104, v6
  s_mov_b64 s[56:57], vcc
  v_cmp_ne_u32_sdwa vcc, v58, v113 src0_sel:BYTE_3 src1_sel:DWORD
  s_and_b64 vcc, vcc, s[56:57]
  s_or_b64 s[58:59], s[58:59], vcc
BV_285:
  v_cmp_lt_u32 vcc, 15, v105
  s_cbranch_vccz BV_286
  v_add_u32 v6, 15, v4
  v_cmp_gt_u32 vcc, v105, v6
  s_mov_b64 s[56:57], vcc
  v_cmp_ne_u32_sdwa vcc, v60, v113 src0_sel:BYTE_3 src1_sel:DWORD
  s_and_b64 vcc, vcc, s[56:57]
  s_or_b64 s[58:59], s[58:59], vcc
  v_add_u32 v6, 16, v4
  v_cmp_gt_u32 vcc, v105, v6
  s_mov_b64 s[56:57], vcc
  v_cmp_ne_u32_sdwa vcc, v62, v113 src0_sel:BYTE_3 src1_sel:DWORD
  s_and_b64 vcc, vcc, s[56:57]
  s_or_b64 s[58:59], s[58:59], vcc
BV_286:
  v_cmp_lt_u32 vcc, 15, v106
  s_cbranch_vccz BV_287
  v_add_u32 v6, 15, v4
  v_cmp_gt_u32 vcc, v106, v6
  s_mov_b64 s[56:57], vcc
  v_cmp_ne_u32_sdwa vcc, v64, v113 src0_sel:BYTE_3 src1_sel:DWORD
  s_and_b64 vcc, vcc, s[56:57]
  s_or_b64 s[58:59], s[58:59], vcc
  v_add_u32 v6, 16, v4
  v_cmp_gt_u32 vcc, v106, v6
  s_mov_b64 s[56:57], vcc
  v_cmp_ne_u32_sdwa vcc, v66, v113 src0_sel:BYTE_3 src1_sel:DWORD
  s_and_b64 vcc, vcc, s[56:57]
  s_or_b64 s[58:59], s[58:59], vcc
BV_287:
  v_cmp_lt_u32 vcc, 15, v107
  s_cbranch_vccz BV_288
  v_add_u32 v6, 15, v4
  v_cmp_gt_u32 vcc, v107, v6
  s_mov_b64 s[56:57], vcc
  v_cmp_ne_u32_sdwa vcc, v68, v113 src0_sel:BYTE_3 src1_sel:DWORD
  s_and_b64 vcc, vcc, s[56:57]
  s_or_b64 s[58:59], s[58:59], vcc
  v_add_u32 v6, 16, v4
  v_cmp_gt_u32 vcc, v107, v6
  s_mov_b64 s[56:57], vcc
  v_cmp_ne_u32_sdwa vcc, v70, v113 src0_sel:BYTE_3 src1_sel:DWORD
  s_and_b64 vcc, vcc, s[56:57]
  s_or_b64 s[58:59], s[58:59], vcc
BV_288:
  v_cmp_lt_u32 vcc, 15, v108
  s_cbranch_vccz BV_289
  v_add_u32 v6, 15, v4
  v_cmp_gt_u32 vcc, v108, v6
  s_mov_b64 s[56:57], vcc
  v_cmp_ne_u32_sdwa vcc, v72, v113 src0_sel:BYTE_3 src1_sel:DWORD
  s_and_b64 vcc, vcc, s[56:57]
  s_or_b64 s[58:59], s[58:59], vcc
  v_add_u32 v6, 16, v4
  v_cmp_gt_u32 vcc, v108, v6
  s_mov_b64 s[56:57], vcc
  v_cmp_ne_u32_sdwa vcc, v74, v113 src0_sel:BYTE_3 src1_sel:DWORD
  s_and_b64 vcc, vcc, s[56:57]
  s_or_b64 s[58:59], s[58:59], vcc
BV_289:
  v_cmp_lt_u32 vcc, 15, v109
  s_cbranch_vccz BV_290
  v_add_u32 v6, 15, v4
  v_cmp_gt_u32 vcc, v109, v6
  s_mov_b64 s[56:57], vcc
  v_cmp_ne_u32_sdwa vcc, v76, v113 src0_sel:BYTE_3 src1_sel:DWORD
  s_and_b64 vcc, vcc, s[56:57]
  s_or_b64 s[58:59], s[58:59], vcc
  v_add_u32 v6, 16, v4
  v_cmp_gt_u32 vcc, v109, v6
  s_mov_b64 s[56:57], vcc
  v_cmp_ne_u32_sdwa vcc, v78, v113 src0_sel:BYTE_3 src1_sel:DWORD
  s_and_b64 vcc, vcc, s[56:57]
  s_or_b64 s[58:59], s[58:59], vcc
BV_290:
  v_cmp_lt_u32 vcc, 15, v110
  s_cbranch_vccz BV_291
  v_add_u32 v6, 15, v4
  v_cmp_gt_u32 vcc, v110, v6
  s_mov_b64 s[56:57], vcc
  v_cmp_ne_u32_sdwa vcc, v80, v113 src0_sel:BYTE_3 src1_sel:DWORD
  s_and_b64 vcc, vcc, s[56:57]
  s_or_b64 s[58:59], s[58:59], vcc
  v_add_u32 v6, 16, v4
  v_cmp_gt_u32 vcc, v110, v6
  s_mov_b64 s[56:57], vcc
  v_cmp_ne_u32_sdwa vcc, v82, v113 src0_sel:BYTE_3 src1_sel:DWORD
  s_and_b64 vcc, vcc, s[56:57]
  s_or_b64 s[58:59], s[58:59], vcc
BV_291:
  v_cmp_lt_u32 vcc, 15, v111
  s_cbranch_vccz BV_292
  v_add_u32 v6, 15, v4
  v_cmp_gt_u32 vcc, v111, v6
  s_mov_b64 s[56:57], vcc
  v_cmp_ne_u32_sdwa vcc, v84, v113 src0_sel:BYTE_3 src1_sel:DWORD
  s_and_b64 vcc, vcc, s[56:57]
  s_or_b64 s[58:59], s[58:59], vcc
  v_add_u32 v6, 16, v4
  v_cmp_gt_u32 vcc, v111, v6
  s_mov_b64 s[56:57], vcc
  v_cmp_ne_u32_sdwa vcc, v86, v113 src0_sel:BYTE_3 src1_sel:DWORD
  s_and_b64 vcc, vcc, s[56:57]
  s_or_b64 s[58:59], s[58:59], vcc
BV_292:
  s_cmp_eq_u64 s[58:59], 0
  s_cbranch_scc1 OKB_275
  s_add_u32 s63, s63, 1
  s_cmp_ge_u32 s63, 20000
  s_cbranch_scc1 TOB_293
  s_sleep 4
  s_branch RETB_274
TOB_293:
  v_mov_b32 v6, 16
  ds_or_b32 v124, v6 offset:1024
OKB_275:
  v_cmp_lt_u32 vcc, 15, v104
  s_cbranch_vccz SJ_294
  v_add_u32 v6, 15, v4
  v_cmp_gt_u32 vcc, v104, v6
  v_lshlrev_b32_sdwa v114, 2, v56 dst_sel:DWORD dst_unused:UNUSED_PAD src0_sel:DWORD src1_sel:BYTE_0
  s_mov_b64 exec, vcc
  ds_add_u32 v114, v125 offset:0
  s_mov_b64 exec, -1
  v_add_u32 v6, 16, v4
  v_cmp_gt_u32 vcc, v104, v6
  v_lshlrev_b32_sdwa v115, 2, v58 dst_sel:DWORD dst_unused:UNUSED_PAD src0_sel:DWORD src1_sel:BYTE_0
  s_mov_b64 exec, vcc
  ds_add_u32 v115, v125 offset:0
  s_mov_b64 exec, -1
SJ_294:
  v_cmp_lt_u32 vcc, 15, v105
  s_cbranch_vccz SJ_295
  v_add_u32 v6, 15, v4
  v_cmp_gt_u32 vcc, v105, v6
  v_lshlrev_b32_sdwa v114, 2, v60 dst_sel:DWORD dst_unused:UNUSED_PAD src0_sel:DWORD src1_sel:BYTE_0
  s_mov_b64 exec, vcc
  ds_add_u32 v114, v125 offset:0
  s_mov_b64 exec, -1
  v_add_u32 v6, 16, v4
  v_cmp_gt_u32 vcc, v105, v6
  v_lshlrev_b32_sdwa v115, 2, v62 dst_sel:DWORD dst_unused:UNUSED_PAD src0_sel:DWORD src1_sel:BYTE_0
  s_mov_b64 exec, vcc
  ds_add_u32 v115, v125 offset:0
  s_mov_b64 exec, -1
SJ_295:
  v_cmp_lt_u32 vcc, 15, v106
  s_cbranch_vccz SJ_296
  v_add_u32 v6, 15, v4
  v_cmp_gt_u32 vcc, v106, v6
  v_lshlrev_b32_sdwa v114, 2, v64 dst_sel:DWORD dst_unused:UNUSED_PAD src0_sel:DWORD src1_sel:BYTE_0
  s_mov_b64 exec, vcc
  ds_add_u32 v114, v125 offset:0
  s_mov_b64 exec, -1
  v_add_u32 v6, 16, v4
  v_cmp_gt_u32 vcc, v106, v6
  v_lshlrev_b32_sdwa v115, 2, v66 dst_sel:DWORD dst_unused:UNUSED_PAD src0_sel:DWORD src1_sel:BYTE_0
  s_mov_b64 exec, vcc
  ds_add_u32 v115, v125 offset:0
  s_mov_b64 exec, -1
SJ_296:
  v_cmp_lt_u32 vcc, 15, v107
  s_cbranch_vccz SJ_297
  v_add_u32 v6, 15, v4
  v_cmp_gt_u32 vcc, v107, v6
  v_lshlrev_b32_sdwa v114, 2, v68 dst_sel:DWORD dst_unused:UNUSED_PAD src0_sel:DWORD src1_sel:BYTE_0
  s_mov_b64 exec, vcc
  ds_add_u32 v114, v125 offset:0
  s_mov_b64 exec, -1
  v_add_u32 v6, 16, v4
  v_cmp_gt_u32 vcc, v107, v6
  v_lshlrev_b32_sdwa v115, 2, v70 dst_sel:DWORD dst_unused:UNUSED_PAD src0_sel:DWORD src1_sel:BYTE_0
  s_mov_b64 exec, vcc
  ds_add_u32 v115, v125 offset:0
  s_mov_b64 exec, -1
SJ_297:
  v_cmp_lt_u32 vcc, 15, v108
  s_cbranch_vccz SJ_298
  v_add_u32 v6, 15, v4
  v_cmp_gt_u32 vcc, v108, v6
  v_lshlrev_b32_sdwa v114, 2, v72 dst_sel:DWORD dst_unused:UNUSED_PAD src0_sel:DWORD src1_sel:BYTE_0
  s_mov_b64 exec, vcc
  ds_add_u32 v114, v125 offset:0
  s_mov_b64 exec, -1
  v_add_u32 v6, 16, v4
  v_cmp_gt_u32 vcc, v108, v6
  v_lshlrev_b32_sdwa v115, 2, v74 dst_sel:DWORD dst_unused:UNUSED_PAD src0_sel:DWORD src1_sel:BYTE_0
  s_mov_b64 exec, vcc
  ds_add_u32 v115, v125 offset:0
  s_mov_b64 exec, -1
SJ_298:
  v_cmp_lt_u32 vcc, 15, v109
  s_cbranch_vccz SJ_299
  v_add_u32 v6, 15, v4
  v_cmp_gt_u32 vcc, v109, v6
  v_lshlrev_b32_sdwa v114, 2, v76 dst_sel:DWORD dst_unused:UNUSED_PAD src0_sel:DWORD src1_sel:BYTE_0
  s_mov_b64 exec, vcc
  ds_add_u32 v114, v125 offset:0
  s_mov_b64 exec, -1
  v_add_u32 v6, 16, v4
  v_cmp_gt_u32 vcc, v109, v6
  v_lshlrev_b32_sdwa v115, 2, v78 dst_sel:DWORD dst_unused:UNUSED_PAD src0_sel:DWORD src1_sel:BYTE_0
  s_mov_b64 exec, vcc
  ds_add_u32 v115, v125 offset:0
  s_mov_b64 exec, -1
SJ_299:
  v_cmp_lt_u32 vcc, 15, v110
  s_cbranch_vccz SJ_300
  v_add_u32 v6, 15, v4
  v_cmp_gt_u32 vcc, v110, v6
  v_lshlrev_b32_sdwa v114, 2, v80 dst_sel:DWORD dst_unused:UNUSED_PAD src0_sel:DWORD src1_sel:BYTE_0
  s_mov_b64 exec, vcc
  ds_add_u32 v114, v125 offset:0
  s_mov_b64 exec, -1
  v_add_u32 v6, 16, v4
  v_cmp_gt_u32 vcc, v110, v6
  v_lshlrev_b32_sdwa v115, 2, v82 dst_sel:DWORD dst_unused:UNUSED_PAD src0_sel:DWORD src1_sel:BYTE_0
  s_mov_b64 exec, vcc
  ds_add_u32 v115, v125 offset:0
  s_mov_b64 exec, -1
SJ_300:
  v_cmp_lt_u32 vcc, 15, v111
  s_cbranch_vccz SJ_301
  v_add_u32 v6, 15, v4
  v_cmp_gt_u32 vcc, v111, v6
  v_lshlrev_b32_sdwa v114, 2, v84 dst_sel:DWORD dst_unused:UNUSED_PAD src0_sel:DWORD src1_sel:BYTE_0
  s_mov_b64 exec, vcc
  ds_add_u32 v114, v125 offset:0
  s_mov_b64 exec, -1
  v_add_u32 v6, 16, v4
  v_cmp_gt_u32 vcc, v111, v6
  v_lshlrev_b32_sdwa v115, 2, v86 dst_sel:DWORD dst_unused:UNUSED_PAD src0_sel:DWORD src1_sel:BYTE_0
  s_mov_b64 exec, vcc
  ds_add_u32 v115, v125 offset:0
  s_mov_b64 exec, -1
SJ_301:
NH2_273:
  s_mov_b64 exec, 1
  ds_add_u32 v124, v125 offset:1104
  s_mov_b64 exec, -1
  v_lshlrev_b32_sdwa v40, 2, v8 dst_sel:DWORD dst_unused:UNUSED_PAD src0_sel:DWORD src1_sel:BYTE_0
  v_and_b32 v8, 0x003fff00, v8
  v_lshlrev_b32_sdwa v41, 2, v10 dst_sel:DWORD dst_unused:UNUSED_PAD src0_sel:DWORD src1_sel:BYTE_0
  v_and_b32 v10, 0x003fff00, v10
  v_lshlrev_b32_sdwa v42, 2, v12 dst_sel:DWORD dst_unused:UNUSED_PAD src0_sel:DWORD src1_sel:BYTE_0
  v_and_b32 v12, 0x003fff00, v12
  v_lshlrev_b32_sdwa v43, 2, v14 dst_sel:DWORD dst_unused:UNUSED_PAD src0_sel:DWORD src1_sel:BYTE_0
  v_and_b32 v14, 0x003fff00, v14
  v_lshlrev_b32_sdwa v44, 2, v16 dst_sel:DWORD dst_unused:UNUSED_PAD src0_sel:DWORD src1_sel:BYTE_0
  v_and_b32 v16, 0x003fff00, v16
  v_lshlrev_b32_sdwa v45, 2, v18 dst_sel:DWORD dst_unused:UNUSED_PAD src0_sel:DWORD src1_sel:BYTE_0
  v_and_b32 v18, 0x003fff00, v18
  v_lshlrev_b32_sdwa v46, 2, v20 dst_sel:DWORD dst_unused:UNUSED_PAD src0_sel:DWORD src1_sel:BYTE_0
  v_and_b32 v20, 0x003fff00, v20
  v_lshlrev_b32_sdwa v47, 2, v22 dst_sel:DWORD dst_unused:UNUSED_PAD src0_sel:DWORD src1_sel:BYTE_0
  v_and_b32 v22, 0x003fff00, v22
  v_lshlrev_b32_sdwa v48, 2, v24 dst_sel:DWORD dst_unused:UNUSED_PAD src0_sel:DWORD src1_sel:BYTE_0
  v_and_b32 v24, 0x003fff00, v24
  v_lshlrev_b32_sdwa v49, 2, v26 dst_sel:DWORD dst_unused:UNUSED_PAD src0_sel:DWORD src1_sel:BYTE_0
  v_and_b32 v26, 0x003fff00, v26
  v_lshlrev_b32_sdwa v50, 2, v28 dst_sel:DWORD dst_unused:UNUSED_PAD src0_sel:DWORD src1_sel:BYTE_0
  v_and_b32 v28, 0x003fff00, v28
  v_lshlrev_b32_sdwa v51, 2, v30 dst_sel:DWORD dst_unused:UNUSED_PAD src0_sel:DWORD src1_sel:BYTE_0
  v_and_b32 v30, 0x003fff00, v30
  v_lshlrev_b32_sdwa v52, 2, v32 dst_sel:DWORD dst_unused:UNUSED_PAD src0_sel:DWORD src1_sel:BYTE_0
  v_and_b32 v32, 0x003fff00, v32
  v_lshlrev_b32_sdwa v53, 2, v34 dst_sel:DWORD dst_unused:UNUSED_PAD src0_sel:DWORD src1_sel:BYTE_0
  v_and_b32 v34, 0x003fff00, v34
  v_lshlrev_b32_sdwa v54, 2, v36 dst_sel:DWORD dst_unused:UNUSED_PAD src0_sel:DWORD src1_sel:BYTE_0
  v_and_b32 v36, 0x003fff00, v36
  v_lshlrev_b32_sdwa v55, 2, v38 dst_sel:DWORD dst_unused:UNUSED_PAD src0_sel:DWORD src1_sel:BYTE_0
  v_and_b32 v38, 0x003fff00, v38
  v_and_b32 v116, 1, v1
  v_lshlrev_b32 v116, 1, v116
  v_xor_b32 v116, 3, v116
  v_lshlrev_b32 v116, 8, v116
  v_mov_b32 v117, 0
  v_subrev_u32 v118, 256, v116
  v_mov_b32 v119, 0
  v_lshlrev_b32 v120, 4, v1
  s_sub_u32 s54, s3, 12
  s_lshl_b32 s54, s54, 13
  s_add_u32 s54, s54, 98304
  v_add_u32 v120, s54, v120
  s_mov_b32 s60, 0
SPIN_302:
  ds_read_b32 v6, v124 offset:1080
  s_waitcnt lgkmcnt(0)
  v_readfirstlane_b32 s54, v6
  s_cmp_ge_u32 s54, 10
  s_cbranch_scc1 SPD_303
  s_add_u32 s60, s60, 1
  s_cmp_lt_u32 s60, 200000
  s_sleep 1
  s_cbranch_scc1 SPIN_302
  v_mov_b32 v6, 16
  ds_or_b32 v124, v6 offset:1024
SPD_303:
  ds_write_b128 v120, v[116:119] offset:0
  ds_write_b128 v120, v[116:119] offset:1024
  ds_write_b128 v120, v[116:119] offset:2048
  ds_write_b128 v120, v[116:119] offset:3072
  ds_write_b128 v120, v[116:119] offset:4096
  ds_write_b128 v120, v[116:119] offset:5120
  ds_write_b128 v120, v[116:119] offset:6144
  ds_write_b128 v120, v[116:119] offset:7168
  s_mov_b64 exec, 1
  ds_add_u32 v124, v125 offset:1172
  s_mov_b64 exec, -1
  v_mov_b32 v113, 32
  s_mov_b32 s60, 0
SPIN_304:
  ds_read_b32 v6, v124 offset:1108
  s_waitcnt lgkmcnt(0)
  v_readfirstlane_b32 s54, v6
  s_cmp_ge_u32 s54, 1
  s_cbranch_scc1 SPD_305
  s_add_u32 s60, s60, 1
  s_cmp_lt_u32 s60, 200000
  s_sleep 1
  s_cbranch_scc1 SPIN_304
  v_mov_b32 v6, 16
  ds_or_b32 v124, v6 offset:1024
SPD_305:
  s_cmp_ge_u32 s54, 0x100
  s_cbranch_scc1 SSKIP_306
  ds_add_rtn_u32 v40, v40, v113 offset:1536
  ds_add_rtn_u32 v42, v42, v113 offset:1536
  ds_add_rtn_u32 v44, v44, v113 offset:1536
  ds_add_rtn_u32 v46, v46, v113 offset:1536
  ds_add_rtn_u32 v48, v48, v113 offset:1536
  ds_add_rtn_u32 v50, v50, v113 offset:1536
  ds_add_rtn_u32 v52, v52, v113 offset:1536
  ds_add_rtn_u32 v54, v54, v113 offset:1536
  s_not_b64 s[56:57], s[88:89]
  s_mov_b64 exec, s[56:57]
  ds_add_rtn_u32 v41, v41, v113 offset:1536
  ds_add_rtn_u32 v43, v43, v113 offset:1536
  ds_add_rtn_u32 v45, v45, v113 offset:1536
  ds_add_rtn_u32 v47, v47, v113 offset:1536
  ds_add_rtn_u32 v49, v49, v113 offset:1536
  ds_add_rtn_u32 v51, v51, v113 offset:1536
  ds_add_rtn_u32 v53, v53, v113 offset:1536
  ds_add_rtn_u32 v55, v55, v113 offset:1536
  s_mov_b64 exec, -1
  s_cmp_eq_u32 s62, 0
  s_cbranch_scc1 NBC_307
  v_cmp_lt_u32 vcc, 15, v104
  s_cbranch_vccz SB_308
  v_lshlrev_b32_sdwa v88, 2, v56 dst_sel:DWORD dst_unused:UNUSED_PAD src0_sel:DWORD src1_sel:BYTE_0
  v_and_b32 v56, 0x003fff00, v56
  v_add_u32 v6, 15, v4
  v_cmp_gt_u32 vcc, v104, v6
  s_mov_b64 exec, vcc
  ds_add_rtn_u32 v88, v88, v113 offset:1536
  s_mov_b64 exec, -1
  v_lshlrev_b32_sdwa v89, 2, v58 dst_sel:DWORD dst_unused:UNUSED_PAD src0_sel:DWORD src1_sel:BYTE_0
  v_and_b32 v58, 0x003fff00, v58
  v_add_u32 v6, 16, v4
  v_cmp_gt_u32 vcc, v104, v6
  s_mov_b64 exec, vcc
  ds_add_rtn_u32 v89, v89, v113 offset:1536
  s_mov_b64 exec, -1
SB_308:
  v_cmp_lt_u32 vcc, 15, v105
  s_cbranch_vccz SB_309
  v_lshlrev_b32_sdwa v90, 2, v60 dst_sel:DWORD dst_unused:UNUSED_PAD src0_sel:DWORD src1_sel:BYTE_0
  v_and_b32 v60, 0x003fff00, v60
  v_add_u32 v6, 15, v4
  v_cmp_gt_u32 vcc, v105, v6
  s_mov_b64 exec, vcc
  ds_add_rtn_u32 v90, v90, v113 offset:1536
  s_mov_b64 exec, -1
  v_lshlrev_b32_sdwa v91, 2, v62 dst_sel:DWORD dst_unused:UNUSED_PAD src0_sel:DWORD src1_sel:BYTE_0
  v_and_b32 v62, 0x003fff00, v62
  v_add_u32 v6, 16, v4
  v_cmp_gt_u32 vcc, v105, v6
  s_mov_b64 exec, vcc
  ds_add_rtn_u32 v91, v91, v113 offset:1536
  s_mov_b64 exec, -1
SB_309:
  v_cmp_lt_u32 vcc, 15, v106
  s_cbranch_vccz SB_310
  v_lshlrev_b32_sdwa v92, 2, v64 dst_sel:DWORD dst_unused:UNUSED_PAD src0_sel:DWORD src1_sel:BYTE_0
  v_and_b32 v64, 0x003fff00, v64
  v_add_u32 v6, 15, v4
  v_cmp_gt_u32 vcc, v106, v6
  s_mov_b64 exec, vcc
  ds_add_rtn_u32 v92, v92, v113 offset:1536
  s_mov_b64 exec, -1
  v_lshlrev_b32_sdwa v93, 2, v66 dst_sel:DWORD dst_unused:UNUSED_PAD src0_sel:DWORD src1_sel:BYTE_0
  v_and_b32 v66, 0x003fff00, v66
  v_add_u32 v6, 16, v4
  v_cmp_gt_u32 vcc, v106, v6
  s_mov_b64 exec, vcc
  ds_add_rtn_u32 v93, v93, v113 offset:1536
  s_mov_b64 exec, -1
SB_310:
  v_cmp_lt_u32 vcc, 15, v107
  s_cbranch_vccz SB_311
  v_lshlrev_b32_sdwa v94, 2, v68 dst_sel:DWORD dst_unused:UNUSED_PAD src0_sel:DWORD src1_sel:BYTE_0
  v_and_b32 v68, 0x003fff00, v68
  v_add_u32 v6, 15, v4
  v_cmp_gt_u32 vcc, v107, v6
  s_mov_b64 exec, vcc
  ds_add_rtn_u32 v94, v94, v113 offset:1536
  s_mov_b64 exec, -1
  v_lshlrev_b32_sdwa v95, 2, v70 dst_sel:DWORD dst_unused:UNUSED_PAD src0_sel:DWORD src1_sel:BYTE_0
  v_and_b32 v70, 0x003fff00, v70
  v_add_u32 v6, 16, v4
  v_cmp_gt_u32 vcc, v107, v6
  s_mov_b64 exec, vcc
  ds_add_rtn_u32 v95, v95, v113 offset:1536
  s_mov_b64 exec, -1
SB_311:
  v_cmp_lt_u32 vcc, 15, v108
  s_cbranch_vccz SB_312
  v_lshlrev_b32_sdwa v96, 2, v72 dst_sel:DWORD dst_unused:UNUSED_PAD src0_sel:DWORD src1_sel:BYTE_0
  v_and_b32 v72, 0x003fff00, v72
  v_add_u32 v6, 15, v4
  v_cmp_gt_u32 vcc, v108, v6
  s_mov_b64 exec, vcc
  ds_add_rtn_u32 v96, v96, v113 offset:1536
  s_mov_b64 exec, -1
  v_lshlrev_b32_sdwa v97, 2, v74 dst_sel:DWORD dst_unused:UNUSED_PAD src0_sel:DWORD src1_sel:BYTE_0
  v_and_b32 v74, 0x003fff00, v74
  v_add_u32 v6, 16, v4
  v_cmp_gt_u32 vcc, v108, v6
  s_mov_b64 exec, vcc
  ds_add_rtn_u32 v97, v97, v113 offset:1536
  s_mov_b64 exec, -1
SB_312:
  v_cmp_lt_u32 vcc, 15, v109
  s_cbranch_vccz SB_313
  v_lshlrev_b32_sdwa v98, 2, v76 dst_sel:DWORD dst_unused:UNUSED_PAD src0_sel:DWORD src1_sel:BYTE_0
  v_and_b32 v76, 0x003fff00, v76
  v_add_u32 v6, 15, v4
  v_cmp_gt_u32 vcc, v109, v6
  s_mov_b64 exec, vcc
  ds_add_rtn_u32 v98, v98, v113 offset:1536
  s_mov_b64 exec, -1
  v_lshlrev_b32_sdwa v99, 2, v78 dst_sel:DWORD dst_unused:UNUSED_PAD src0_sel:DWORD src1_sel:BYTE_0
  v_and_b32 v78, 0x003fff00, v78
  v_add_u32 v6, 16, v4
  v_cmp_gt_u32 vcc, v109, v6
  s_mov_b64 exec, vcc
  ds_add_rtn_u32 v99, v99, v113 offset:1536
  s_mov_b64 exec, -1
SB_313:
  v_cmp_lt_u32 vcc, 15, v110
  s_cbranch_vccz SB_314
  v_lshlrev_b32_sdwa v100, 2, v80 dst_sel:DWORD dst_unused:UNUSED_PAD src0_sel:DWORD src1_sel:BYTE_0
  v_and_b32 v80, 0x003fff00, v80
  v_add_u32 v6, 15, v4
  v_cmp_gt_u32 vcc, v110, v6
  s_mov_b64 exec, vcc
  ds_add_rtn_u32 v100, v100, v113 offset:1536
  s_mov_b64 exec, -1
  v_lshlrev_b32_sdwa v101, 2, v82 dst_sel:DWORD dst_unused:UNUSED_PAD src0_sel:DWORD src1_sel:BYTE_0
  v_and_b32 v82, 0x003fff00, v82
  v_add_u32 v6, 16, v4
  v_cmp_gt_u32 vcc, v110, v6
  s_mov_b64 exec, vcc
  ds_add_rtn_u32 v101, v101, v113 offset:1536
  s_mov_b64 exec, -1
SB_314:
  v_cmp_lt_u32 vcc, 15, v111
  s_cbranch_vccz SB_315
  v_lshlrev_b32_sdwa v102, 2, v84 dst_sel:DWORD dst_unused:UNUSED_PAD src0_sel:DWORD src1_sel:BYTE_0
  v_and_b32 v84, 0x003fff00, v84
  v_add_u32 v6, 15, v4
  v_cmp_gt_u32 vcc, v111, v6
  s_mov_b64 exec, vcc
  ds_add_rtn_u32 v102, v102, v113 offset:1536
  s_mov_b64 exec, -1
  v_lshlrev_b32_sdwa v103, 2, v86 dst_sel:DWORD dst_unused:UNUSED_PAD src0_sel:DWORD src1_sel:BYTE_0
  v_and_b32 v86, 0x003fff00, v86
  v_add_u32 v6, 16, v4
  v_cmp_gt_u32 vcc, v111, v6
  s_mov_b64 exec, vcc
  ds_add_rtn_u32 v103, v103, v113 offset:1536
  s_mov_b64 exec, -1
SB_315:
NBC_307:
  s_waitcnt lgkmcnt(0)
  v_bfe_u32 v114, v40, 3, 2
  v_xor_b32 v114, 3, v114
  v_lshl_add_u32 v8, v114, 8, v8
  v_bfe_u32 v114, v41, 3, 2
  v_xor_b32 v114, 3, v114
  v_lshl_add_u32 v10, v114, 8, v10
  v_bfe_u32 v114, v42, 3, 2
  v_xor_b32 v114, 3, v114
  v_lshl_add_u32 v12, v114, 8, v12
  v_bfe_u32 v114, v43, 3, 2
  v_xor_b32 v114, 3, v114
  v_lshl_add_u32 v14, v114, 8, v14
  v_bfe_u32 v114, v44, 3, 2
  v_xor_b32 v114, 3, v114
  v_lshl_add_u32 v16, v114, 8, v16
  v_bfe_u32 v114, v45, 3, 2
  v_xor_b32 v114, 3, v114
  v_lshl_add_u32 v18, v114, 8, v18
  v_bfe_u32 v114, v46, 3, 2
  v_xor_b32 v114, 3, v114
  v_lshl_add_u32 v20, v114, 8, v20
  v_bfe_u32 v114, v47, 3, 2
  v_xor_b32 v114, 3, v114
  v_lshl_add_u32 v22, v114, 8, v22
  v_bfe_u32 v114, v48, 3, 2
  v_xor_b32 v114, 3, v114
  v_lshl_add_u32 v24, v114, 8, v24
  v_bfe_u32 v114, v49, 3, 2
  v_xor_b32 v114, 3, v114
  v_lshl_add_u32 v26, v114, 8, v26
  v_bfe_u32 v114, v50, 3, 2
  v_xor_b32 v114, 3, v114
  v_lshl_add_u32 v28, v114, 8, v28
  v_bfe_u32 v114, v51, 3, 2
  v_xor_b32 v114, 3, v114
  v_lshl_add_u32 v30, v114, 8, v30
  v_bfe_u32 v114, v52, 3, 2
  v_xor_b32 v114, 3, v114
  v_lshl_add_u32 v32, v114, 8, v32
  v_bfe_u32 v114, v53, 3, 2
  v_xor_b32 v114, 3, v114
  v_lshl_add_u32 v34, v114, 8, v34
  v_bfe_u32 v114, v54, 3, 2
  v_xor_b32 v114, 3, v114
  v_lshl_add_u32 v36, v114, 8, v36
  v_bfe_u32 v114, v55, 3, 2
  v_xor_b32 v114, 3, v114
  v_lshl_add_u32 v38, v114, 8, v38
  s_mov_b32 s60, 0
SPIN_316:
  ds_read_b32 v6, v124 offset:1172
  s_waitcnt lgkmcnt(0)
  v_readfirstlane_b32 s54, v6
  s_cmp_ge_u32 s54, 4
  s_cbranch_scc1 SPD_317
  s_add_u32 s60, s60, 1
  s_cmp_lt_u32 s60, 200000
  s_sleep 1
  s_cbranch_scc1 SPIN_316
  v_mov_b32 v6, 16
  ds_or_b32 v124, v6 offset:1024
SPD_317:
  ds_write_b64 v40, v[8:9]
  ds_write_b64 v42, v[12:13]
  ds_write_b64 v44, v[16:17]
  ds_write_b64 v46, v[20:21]
  ds_write_b64 v48, v[24:25]
  ds_write_b64 v50, v[28:29]
  ds_write_b64 v52, v[32:33]
  ds_write_b64 v54, v[36:37]
  s_not_b64 s[56:57], s[88:89]
  s_mov_b64 exec, s[56:57]
  ds_write_b64 v41, v[10:11]
  ds_write_b64 v43, v[14:15]
  ds_write_b64 v45, v[18:19]
  ds_write_b64 v47, v[22:23]
  ds_write_b64 v49, v[26:27]
  ds_write_b64 v51, v[30:31]
  ds_write_b64 v53, v[34:35]
  ds_write_b64 v55, v[38:39]
  s_mov_b64 exec, -1
  s_cmp_eq_u32 s62, 0
  s_cbranch_scc1 NS2_318
  v_cmp_lt_u32 vcc, 15, v104
  s_cbranch_vccz SB_319
  v_bfe_u32 v114, v88, 3, 2
  v_xor_b32 v114, 3, v114
  v_lshl_add_u32 v56, v114, 8, v56
  v_add_u32 v6, 15, v4
  v_cmp_gt_u32 vcc, v104, v6
  s_mov_b64 exec, vcc
  ds_write_b64 v88, v[56:57]
  s_mov_b64 exec, -1
  v_bfe_u32 v114, v89, 3, 2
  v_xor_b32 v114, 3, v114
  v_lshl_add_u32 v58, v114, 8, v58
  v_add_u32 v6, 16, v4
  v_cmp_gt_u32 vcc, v104, v6
  s_mov_b64 exec, vcc
  ds_write_b64 v89, v[58:59]
  s_mov_b64 exec, -1
SB_319:
  v_cmp_lt_u32 vcc, 15, v105
  s_cbranch_vccz SB_320
  v_bfe_u32 v114, v90, 3, 2
  v_xor_b32 v114, 3, v114
  v_lshl_add_u32 v60, v114, 8, v60
  v_add_u32 v6, 15, v4
  v_cmp_gt_u32 vcc, v105, v6
  s_mov_b64 exec, vcc
  ds_write_b64 v90, v[60:61]
  s_mov_b64 exec, -1
  v_bfe_u32 v114, v91, 3, 2
  v_xor_b32 v114, 3, v114
  v_lshl_add_u32 v62, v114, 8, v62
  v_add_u32 v6, 16, v4
  v_cmp_gt_u32 vcc, v105, v6
  s_mov_b64 exec, vcc
  ds_write_b64 v91, v[62:63]
  s_mov_b64 exec, -1
SB_320:
  v_cmp_lt_u32 vcc, 15, v106
  s_cbranch_vccz SB_321
  v_bfe_u32 v114, v92, 3, 2
  v_xor_b32 v114, 3, v114
  v_lshl_add_u32 v64, v114, 8, v64
  v_add_u32 v6, 15, v4
  v_cmp_gt_u32 vcc, v106, v6
  s_mov_b64 exec, vcc
  ds_write_b64 v92, v[64:65]
  s_mov_b64 exec, -1
  v_bfe_u32 v114, v93, 3, 2
  v_xor_b32 v114, 3, v114
  v_lshl_add_u32 v66, v114, 8, v66
  v_add_u32 v6, 16, v4
  v_cmp_gt_u32 vcc, v106, v6
  s_mov_b64 exec, vcc
  ds_write_b64 v93, v[66:67]
  s_mov_b64 exec, -1
SB_321:
  v_cmp_lt_u32 vcc, 15, v107
  s_cbranch_vccz SB_322
  v_bfe_u32 v114, v94, 3, 2
  v_xor_b32 v114, 3, v114
  v_lshl_add_u32 v68, v114, 8, v68
  v_add_u32 v6, 15, v4
  v_cmp_gt_u32 vcc, v107, v6
  s_mov_b64 exec, vcc
  ds_write_b64 v94, v[68:69]
  s_mov_b64 exec, -1
  v_bfe_u32 v114, v95, 3, 2
  v_xor_b32 v114, 3, v114
  v_lshl_add_u32 v70, v114, 8, v70
  v_add_u32 v6, 16, v4
  v_cmp_gt_u32 vcc, v107, v6
  s_mov_b64 exec, vcc
  ds_write_b64 v95, v[70:71]
  s_mov_b64 exec, -1
SB_322:
  v_cmp_lt_u32 vcc, 15, v108
  s_cbranch_vccz SB_323
  v_bfe_u32 v114, v96, 3, 2
  v_xor_b32 v114, 3, v114
  v_lshl_add_u32 v72, v114, 8, v72
  v_add_u32 v6, 15, v4
  v_cmp_gt_u32 vcc, v108, v6
  s_mov_b64 exec, vcc
  ds_write_b64 v96, v[72:73]
  s_mov_b64 exec, -1
  v_bfe_u32 v114, v97, 3, 2
  v_xor_b32 v114, 3, v114
  v_lshl_add_u32 v74, v114, 8, v74
  v_add_u32 v6, 16, v4
  v_cmp_gt_u32 vcc, v108, v6
  s_mov_b64 exec, vcc
  ds_write_b64 v97, v[74:75]
  s_mov_b64 exec, -1
SB_323:
  v_cmp_lt_u32 vcc, 15, v109
  s_cbranch_vccz SB_324
  v_bfe_u32 v114, v98, 3, 2
  v_xor_b32 v114, 3, v114
  v_lshl_add_u32 v76, v114, 8, v76
  v_add_u32 v6, 15, v4
  v_cmp_gt_u32 vcc, v109, v6
  s_mov_b64 exec, vcc
  ds_write_b64 v98, v[76:77]
  s_mov_b64 exec, -1
  v_bfe_u32 v114, v99, 3, 2
  v_xor_b32 v114, 3, v114
  v_lshl_add_u32 v78, v114, 8, v78
  v_add_u32 v6, 16, v4
  v_cmp_gt_u32 vcc, v109, v6
  s_mov_b64 exec, vcc
  ds_write_b64 v99, v[78:79]
  s_mov_b64 exec, -1
SB_324:
  v_cmp_lt_u32 vcc, 15, v110
  s_cbranch_vccz SB_325
  v_bfe_u32 v114, v100, 3, 2
  v_xor_b32 v114, 3, v114
  v_lshl_add_u32 v80, v114, 8, v80
  v_add_u32 v6, 15, v4
  v_cmp_gt_u32 vcc, v110, v6
  s_mov_b64 exec, vcc
  ds_write_b64 v100, v[80:81]
  s_mov_b64 exec, -1
  v_bfe_u32 v114, v101, 3, 2
  v_xor_b32 v114, 3, v114
  v_lshl_add_u32 v82, v114, 8, v82
  v_add_u32 v6, 16, v4
  v_cmp_gt_u32 vcc, v110, v6
  s_mov_b64 exec, vcc
  ds_write_b64 v101, v[82:83]
  s_mov_b64 exec, -1
SB_325:
  v_cmp_lt_u32 vcc, 15, v111
  s_cbranch_vccz SB_326
  v_bfe_u32 v114, v102, 3, 2
  v_xor_b32 v114, 3, v114
  v_lshl_add_u32 v84, v114, 8, v84
  v_add_u32 v6, 15, v4
  v_cmp_gt_u32 vcc, v111, v6
  s_mov_b64 exec, vcc
  ds_write_b64 v102, v[84:85]
  s_mov_b64 exec, -1
  v_bfe_u32 v114, v103, 3, 2
  v_xor_b32 v114, 3, v114
  v_lshl_add_u32 v86, v114, 8, v86
  v_add_u32 v6, 16, v4
  v_cmp_gt_u32 vcc, v111, v6
  s_mov_b64 exec, vcc
  ds_write_b64 v103, v[86:87]
  s_mov_b64 exec, -1
SB_326:
NS2_318:
SSKIP_306:
  s_setprio 0
  s_branch BMAIN_216
GW_213:
  v_lshrrev_b32 v4, 4, v1
  v_and_b32 v13, 7, v1
  v_xor_b32 v13, v13, v4
  v_lshlrev_b32 v13, 4, v13
  v_lshrrev_b32 v4, 3, v1
  v_lshlrev_b32 v4, 9, v4
  v_add_u32 v13, v13, v4
  s_and_b32 s54, s3, 1
  s_lshl_b32 s54, s54, 6
  v_xor_b32 v13, s54, v13
  s_lshl_b32 s64, s3, 10
  s_lshl_b32 s65, s3, 12
  s_mul_i32 s54, s92, 80384
  s_add_u32 s56, s4, s54
  s_addc_u32 s57, s5, 0
  s_sub_u32 s55, 5120000, s54
  s_mov_b32 s44, s56
  s_and_b32 s45, s57, 0xffff
  s_mov_b32 s46, s55
  s_mov_b32 s47, 0x00020000
  s_add_u32 m0, s64, 16384
  s_lshl_b32 s70, s48, 7
  s_add_u32 s70, s70, s65
  s_add_u32 s70, s70, 0
  buffer_load_dwordx4 v13, s[44:47], s70 offen lds
  s_add_u32 m0, s64, 26624
  s_lshl_b32 s70, s48, 7
  s_add_u32 s70, s70, s65
  s_add_u32 s70, s70, 40960
  buffer_load_dwordx4 v13, s[44:47], s70 offen lds
  s_cmp_ge_u32 s3, 5
  s_cselect_b32 s62, 1, 0
  s_mul_i32 s54, s62, 5
  s_sub_u32 s61, s3, s54
  v_lshrrev_b32 v4, 1, v1
  v_and_b32 v4, 7, v4
  v_lshrrev_b32 v5, 5, v1
  v_xor_b32 v4, v4, v5
  v_and_b32 v5, 31, v1
  v_lshlrev_b32 v5, 7, v5
  s_lshl_b32 s54, s61, 12
  s_add_u32 s54, s54, 16384
  v_add_u32 v5, s54, v5
  v_xor_b32 v8, 0, v4
  v_lshl_add_u32 v8, v8, 4, v5
  v_xor_b32 v9, 2, v4
  v_lshl_add_u32 v9, v9, 4, v5
  v_xor_b32 v10, 4, v4
  v_lshl_add_u32 v10, v10, 4, v5
  v_xor_b32 v11, 6, v4
  v_lshl_add_u32 v11, v11, 4, v5
  v_lshrrev_b32 v4, 4, v1
  v_and_b32 v4, 1, v4
  v_lshlrev_b32 v4, 1, v4
  v_bfe_u32 v5, v1, 1, 1
  v_add_u32 v4, v4, v5
  s_lshl_b32 s54, s62, 2
  v_add_u32 v4, s54, v4
  v_bfe_u32 v5, v1, 3, 1
  v_lshlrev_b32 v5, 2, v5
  v_xor_b32 v4, v4, v5
  v_lshlrev_b32 v12, 4, v4
  v_and_b32 v4, 1, v1
  v_lshl_add_u32 v12, v4, 3, v12
  v_bfe_u32 v4, v1, 2, 2
  v_lshrrev_b32 v5, 5, v1
  v_lshl_add_u32 v4, v5, 3, v4
  v_lshl_add_u32 v12, v4, 7, v12
  v_add_u32 v12, 98304, v12
  v_mov_b32 v52, 0
  v_mov_b32 v68, 0
  v_mov_b32 v53, 0
  v_mov_b32 v69, 0
  v_mov_b32 v54, 0
  v_mov_b32 v70, 0
  v_mov_b32 v55, 0
  v_mov_b32 v71, 0
  v_mov_b32 v56, 0
  v_mov_b32 v72, 0
  v_mov_b32 v57, 0
  v_mov_b32 v73, 0
  v_mov_b32 v58, 0
  v_mov_b32 v74, 0
  v_mov_b32 v59, 0
  v_mov_b32 v75, 0
  v_mov_b32 v60, 0
  v_mov_b32 v76, 0
  v_mov_b32 v61, 0
  v_mov_b32 v77, 0
  v_mov_b32 v62, 0
  v_mov_b32 v78, 0
  v_mov_b32 v63, 0
  v_mov_b32 v79, 0
  v_mov_b32 v64, 0
  v_mov_b32 v80, 0
  v_mov_b32 v65, 0
  v_mov_b32 v81, 0
  v_mov_b32 v66, 0
  v_mov_b32 v82, 0
  v_mov_b32 v67, 0
  v_mov_b32 v83, 0
  s_waitcnt vmcnt(0)
  s_mov_b64 exec, 1
  ds_add_u32 v124, v125 offset:1028
  s_mov_b64 exec, -1
  s_add_u32 m0, s64, 36864
  s_lshl_b32 s70, s49, 7
  s_add_u32 s70, s70, s65
  s_add_u32 s70, s70, 0
  buffer_load_dwordx4 v13, s[44:47], s70 offen lds
  s_add_u32 m0, s64, 47104
  s_lshl_b32 s70, s49, 7
  s_add_u32 s70, s70, s65
  s_add_u32 s70, s70, 40960
  buffer_load_dwordx4 v13, s[44:47], s70 offen lds
  s_mov_b32 s60, 0
SPIN_327:
  ds_read_b32 v6, v124 offset:1028
  s_waitcnt lgkmcnt(0)
  v_readfirstlane_b32 s54, v6
  s_cmp_ge_u32 s54, 14
  s_cbranch_scc1 SPD_328
  s_add_u32 s60, s60, 1
  s_cmp_lt_u32 s60, 200000
  s_sleep 1
  s_cbranch_scc1 SPIN_327
  v_mov_b32 v6, 16
  ds_or_b32 v124, v6 offset:1024
SPD_328:
  ds_read_b128 v[16:19], v8 offset:0
  ds_read_b64_tr_b16 v[20:21], v12 offset:0
  ds_read_b64_tr_b16 v[22:23], v12 offset:512
  ds_read_b64_tr_b16 v[24:25], v12 offset:8192
  ds_read_b64_tr_b16 v[26:27], v12 offset:8704
  ds_read_b128 v[28:31], v9 offset:0
  ds_read_b64_tr_b16 v[32:33], v12 offset:2048
  ds_read_b64_tr_b16 v[34:35], v12 offset:2560
  ds_read_b64_tr_b16 v[36:37], v12 offset:10240
  ds_read_b64_tr_b16 v[38:39], v12 offset:10752
  ds_read_b128 v[40:43], v10 offset:0
  ds_read_b64_tr_b16 v[44:45], v12 offset:4096
  ds_read_b64_tr_b16 v[46:47], v12 offset:4608
  ds_read_b64_tr_b16 v[48:49], v12 offset:12288
  ds_read_b64_tr_b16 v[50:51], v12 offset:12800
  s_waitcnt lgkmcnt(10)
  v_mfma_f32_32x32x16_bf16 v[52:67], v[20:23], v[16:19], v[52:67]
  v_mfma_f32_32x32x16_bf16 v[68:83], v[24:27], v[16:19], v[68:83]
  s_waitcnt vmcnt(0)
  s_mov_b64 exec, 1
  ds_add_u32 v124, v125 offset:1032
  s_mov_b64 exec, -1
  s_add_u32 m0, s64, 57344
  s_lshl_b32 s70, s50, 7
  s_add_u32 s70, s70, s65
  s_add_u32 s70, s70, 0
  buffer_load_dwordx4 v13, s[44:47], s70 offen lds
  s_add_u32 m0, s64, 67584
  s_lshl_b32 s70, s50, 7
  s_add_u32 s70, s70, s65
  s_add_u32 s70, s70, 40960
  buffer_load_dwordx4 v13, s[44:47], s70 offen lds
  ds_read_b32 v7, v124 offset:1032
  ds_read_b128 v[16:19], v11 offset:0
  ds_read_b64_tr_b16 v[20:21], v12 offset:6144
  ds_read_b64_tr_b16 v[22:23], v12 offset:6656
  ds_read_b64_tr_b16 v[24:25], v12 offset:14336
  ds_read_b64_tr_b16 v[26:27], v12 offset:14848
  s_waitcnt lgkmcnt(10)
  v_mfma_f32_32x32x16_bf16 v[52:67], v[32:35], v[28:31], v[52:67]
  v_mfma_f32_32x32x16_bf16 v[68:83], v[36:39], v[28:31], v[68:83]
  s_waitcnt lgkmcnt(5)
  v_readfirstlane_b32 s54, v7
  s_cmp_ge_u32 s54, 14
  s_cbranch_scc1 RDOK_329
  s_mov_b32 s60, 0
SPIN_330:
  ds_read_b32 v6, v124 offset:1032
  s_waitcnt lgkmcnt(0)
  v_readfirstlane_b32 s54, v6
  s_cmp_ge_u32 s54, 14
  s_cbranch_scc1 SPD_331
  s_add_u32 s60, s60, 1
  s_cmp_lt_u32 s60, 200000
  s_sleep 1
  s_cbranch_scc1 SPIN_330
  v_mov_b32 v6, 16
  ds_or_b32 v124, v6 offset:1024
SPD_331:
RDOK_329:
  ds_read_b128 v[28:31], v8 offset:20480
  ds_read_b64_tr_b16 v[32:33], v12 offset:16384
  ds_read_b64_tr_b16 v[34:35], v12 offset:16896
  ds_read_b64_tr_b16 v[36:37], v12 offset:24576
  ds_read_b64_tr_b16 v[38:39], v12 offset:25088
  s_waitcnt lgkmcnt(10)
  v_mfma_f32_32x32x16_bf16 v[52:67], v[44:47], v[40:43], v[52:67]
  v_mfma_f32_32x32x16_bf16 v[68:83], v[48:51], v[40:43], v[68:83]
  ds_read_b128 v[40:43], v9 offset:20480
  ds_read_b64_tr_b16 v[44:45], v12 offset:18432
  ds_read_b64_tr_b16 v[46:47], v12 offset:18944
  ds_read_b64_tr_b16 v[48:49], v12 offset:26624
  ds_read_b64_tr_b16 v[50:51], v12 offset:27136
  s_waitcnt lgkmcnt(10)
  v_mfma_f32_32x32x16_bf16 v[52:67], v[20:23], v[16:19], v[52:67]
  v_mfma_f32_32x32x16_bf16 v[68:83], v[24:27], v[16:19], v[68:83]
  s_mov_b64 exec, 1
  ds_add_u32 v124, v125 offset:1060
  s_mov_b64 exec, -1
  ds_read_b128 v[16:19], v10 offset:20480
  ds_read_b64_tr_b16 v[20:21], v12 offset:20480
  ds_read_b64_tr_b16 v[22:23], v12 offset:20992
  ds_read_b64_tr_b16 v[24:25], v12 offset:28672
  ds_read_b64_tr_b16 v[26:27], v12 offset:29184
  s_waitcnt lgkmcnt(10)
  v_mfma_f32_32x32x16_bf16 v[52:67], v[32:35], v[28:31], v[52:67]
  v_mfma_f32_32x32x16_bf16 v[68:83], v[36:39], v[28:31], v[68:83]
  s_waitcnt vmcnt(0)
  s_mov_b64 exec, 1
  ds_add_u32 v124, v125 offset:1036
  s_mov_b64 exec, -1
  s_add_u32 m0, s64, 77824
  s_lshl_b32 s70, s51, 7
  s_add_u32 s70, s70, s65
  s_add_u32 s70, s70, 0
  buffer_load_dwordx4 v13, s[44:47], s70 offen lds
  s_add_u32 m0, s64, 88064
  s_lshl_b32 s70, s51, 7
  s_add_u32 s70, s70, s65
  s_add_u32 s70, s70, 40960
  buffer_load_dwordx4 v13, s[44:47], s70 offen lds
  ds_read_b32 v7, v124 offset:1036
  ds_read_b128 v[28:31], v11 offset:20480
  ds_read_b64_tr_b16 v[32:33], v12 offset:22528
  ds_read_b64_tr_b16 v[34:35], v12 offset:23040
  ds_read_b64_tr_b16 v[36:37], v12 offset:30720
  ds_read_b64_tr_b16 v[38:39], v12 offset:31232
  s_waitcnt lgkmcnt(10)
  v_mfma_f32_32x32x16_bf16 v[52:67], v[44:47], v[40:43], v[52:67]
  v_mfma_f32_32x32x16_bf16 v[68:83], v[48:51], v[40:43], v[68:83]
  s_waitcnt lgkmcnt(5)
  v_readfirstlane_b32 s54, v7
  s_cmp_ge_u32 s54, 14
  s_cbranch_scc1 RDOK_332
  s_mov_b32 s60, 0
SPIN_333:
  ds_read_b32 v6, v124 offset:1036
  s_waitcnt lgkmcnt(0)
  v_readfirstlane_b32 s54, v6
  s_cmp_ge_u32 s54, 14
  s_cbranch_scc1 SPD_334
  s_add_u32 s60, s60, 1
  s_cmp_lt_u32 s60, 200000
  s_sleep 1
  s_cbranch_scc1 SPIN_333
  v_mov_b32 v6, 16
  ds_or_b32 v124, v6 offset:1024
SPD_334:
RDOK_332:
  ds_read_b128 v[40:43], v8 offset:40960
  ds_read_b64_tr_b16 v[44:45], v12 offset:32768
  ds_read_b64_tr_b16 v[46:47], v12 offset:33280
  ds_read_b64_tr_b16 v[48:49], v12 offset:40960
  ds_read_b64_tr_b16 v[50:51], v12 offset:41472
  s_waitcnt lgkmcnt(10)
  v_mfma_f32_32x32x16_bf16 v[52:67], v[20:23], v[16:19], v[52:67]
  v_mfma_f32_32x32x16_bf16 v[68:83], v[24:27], v[16:19], v[68:83]
  ds_read_b128 v[16:19], v9 offset:40960
  ds_read_b64_tr_b16 v[20:21], v12 offset:34816
  ds_read_b64_tr_b16 v[22:23], v12 offset:35328
  ds_read_b64_tr_b16 v[24:25], v12 offset:43008
  ds_read_b64_tr_b16 v[26:27], v12 offset:43520
  s_waitcnt lgkmcnt(10)
  v_mfma_f32_32x32x16_bf16 v[52:67], v[32:35], v[28:31], v[52:67]
  v_mfma_f32_32x32x16_bf16 v[68:83], v[36:39], v[28:31], v[68:83]
  s_mov_b64 exec, 1
  ds_add_u32 v124, v125 offset:1064
  s_mov_b64 exec, -1
  ds_read_b128 v[28:31], v10 offset:40960
  ds_read_b64_tr_b16 v[32:33], v12 offset:36864
  ds_read_b64_tr_b16 v[34:35], v12 offset:37376
  ds_read_b64_tr_b16 v[36:37], v12 offset:45056
  ds_read_b64_tr_b16 v[38:39], v12 offset:45568
  s_waitcnt lgkmcnt(10)
  v_mfma_f32_32x32x16_bf16 v[52:67], v[44:47], v[40:43], v[52:67]
  v_mfma_f32_32x32x16_bf16 v[68:83], v[48:51], v[40:43], v[68:83]
  s_waitcnt vmcnt(0)
  s_mov_b64 exec, 1
  ds_add_u32 v124, v125 offset:1040
  s_mov_b64 exec, -1
  ds_read_b32 v7, v124 offset:1040
  ds_read_b128 v[40:43], v11 offset:40960
  ds_read_b64_tr_b16 v[44:45], v12 offset:38912
  ds_read_b64_tr_b16 v[46:47], v12 offset:39424
  ds_read_b64_tr_b16 v[48:49], v12 offset:47104
  ds_read_b64_tr_b16 v[50:51], v12 offset:47616
  s_waitcnt lgkmcnt(10)
  v_mfma_f32_32x32x16_bf16 v[52:67], v[20:23], v[16:19], v[52:67]
  v_mfma_f32_32x32x16_bf16 v[68:83], v[24:27], v[16:19], v[68:83]
  s_waitcnt lgkmcnt(5)
  v_readfirstlane_b32 s54, v7
  s_cmp_ge_u32 s54, 14
  s_cbranch_scc1 RDOK_335
  s_mov_b32 s60, 0
SPIN_336:
  ds_read_b32 v6, v124 offset:1040
  s_waitcnt lgkmcnt(0)
  v_readfirstlane_b32 s54, v6
  s_cmp_ge_u32 s54, 14
  s_cbranch_scc1 SPD_337
  s_add_u32 s60, s60, 1
  s_cmp_lt_u32 s60, 200000
  s_sleep 1
  s_cbranch_scc1 SPIN_336
  v_mov_b32 v6, 16
  ds_or_b32 v124, v6 offset:1024
SPD_337:
RDOK_335:
  ds_read_b128 v[16:19], v8 offset:61440
  ds_read_b64_tr_b16 v[20:21], v12 offset:49152
  ds_read_b64_tr_b16 v[22:23], v12 offset:49664
  ds_read_b64_tr_b16 v[24:25], v12 offset:57344
  ds_read_b64_tr_b16 v[26:27], v12 offset:57856
  s_waitcnt lgkmcnt(10)
  v_mfma_f32_32x32x16_bf16 v[52:67], v[32:35], v[28:31], v[52:67]
  v_mfma_f32_32x32x16_bf16 v[68:83], v[36:39], v[28:31], v[68:83]
  ds_read_b128 v[28:31], v9 offset:61440
  ds_read_b64_tr_b16 v[32:33], v12 offset:51200
  ds_read_b64_tr_b16 v[34:35], v12 offset:51712
  ds_read_b64_tr_b16 v[36:37], v12 offset:59392
  ds_read_b64_tr_b16 v[38:39], v12 offset:59904
  s_waitcnt lgkmcnt(10)
  v_mfma_f32_32x32x16_bf16 v[52:67], v[44:47], v[40:43], v[52:67]
  v_mfma_f32_32x32x16_bf16 v[68:83], v[48:51], v[40:43], v[68:83]
  s_mov_b64 exec, 1
  ds_add_u32 v124, v125 offset:1068
  s_mov_b64 exec, -1
  ds_read_b128 v[40:43], v10 offset:61440
  ds_read_b64_tr_b16 v[44:45], v12 offset:53248
  ds_read_b64_tr_b16 v[46:47], v12 offset:53760
  ds_read_b64_tr_b16 v[48:49], v12 offset:61440
  ds_read_b64_tr_b16 v[50:51], v12 offset:61952
  s_waitcnt lgkmcnt(10)
  v_mfma_f32_32x32x16_bf16 v[52:67], v[20:23], v[16:19], v[52:67]
  v_mfma_f32_32x32x16_bf16 v[68:83], v[24:27], v[16:19], v[68:83]
  ds_read_b128 v[16:19], v11 offset:61440
  ds_read_b64_tr_b16 v[20:21], v12 offset:55296
  ds_read_b64_tr_b16 v[22:23], v12 offset:55808
  ds_read_b64_tr_b16 v[24:25], v12 offset:63488
  ds_read_b64_tr_b16 v[26:27], v12 offset:64000
  s_waitcnt lgkmcnt(10)
  v_mfma_f32_32x32x16_bf16 v[52:67], v[32:35], v[28:31], v[52:67]
  v_mfma_f32_32x32x16_bf16 v[68:83], v[36:39], v[28:31], v[68:83]
  s_waitcnt lgkmcnt(5)
  v_mfma_f32_32x32x16_bf16 v[52:67], v[44:47], v[40:43], v[52:67]
  v_mfma_f32_32x32x16_bf16 v[68:83], v[48:51], v[40:43], v[68:83]
  s_waitcnt lgkmcnt(0)
  v_mfma_f32_32x32x16_bf16 v[52:67], v[20:23], v[16:19], v[52:67]
  v_mfma_f32_32x32x16_bf16 v[68:83], v[24:27], v[16:19], v[68:83]
  s_mov_b64 exec, 1
  ds_add_u32 v124, v125 offset:1072
  s_mov_b64 exec, -1
  s_mul_i32 s54, s93, 2560000
  s_mul_i32 s55, s92, 40192
  s_add_u32 s54, s54, s55
  s_add_u32 s54, s54, 4096
  s_add_u32 s56, s26, s54
  s_addc_u32 s57, s27, 0
  s_sub_u32 s55, 2560000, s55
  s_min_u32 s55, s55, 40192
  s_mov_b32 s28, s56
  s_and_b32 s29, s57, 0xffff
  s_mov_b32 s30, s55
  s_mov_b32 s31, 0x00020000
  s_mov_b32 s56, 0xbfb8aa3b
  s_mov_b32 s57, 0xbfb8aa3b
  v_and_b32 v108, 15, v1
  v_lshlrev_b32 v108, 8, v108
  v_bfe_u32 v109, v1, 4, 1
  v_lshl_add_u32 v108, v109, 5, v108
  v_lshrrev_b32 v109, 5, v1
  v_lshl_add_u32 v108, v109, 4, v108
  s_lshl_b32 s54, s61, 13
  s_lshl_b32 s55, s62, 7
  s_add_u32 s54, s54, s55
  s_add_u32 s55, s54, 4096
  v_pk_mul_f32 v[52:53], v[52:53], s[56:57]
  v_pk_mul_f32 v[54:55], v[54:55], s[56:57]
  v_cvt_pk_bf16_f32 v94, v68, v69
  v_cvt_pk_bf16_f32 v95, v70, v71
  v_cvt_pk_bf16_f32 v92, v52, v53
  v_cvt_pk_bf16_f32 v93, v54, v55
  v_pk_mul_f32 v[56:57], v[56:57], s[56:57]
  v_pk_mul_f32 v[58:59], v[58:59], s[56:57]
  v_cvt_pk_bf16_f32 v98, v72, v73
  v_cvt_pk_bf16_f32 v99, v74, v75
  v_cvt_pk_bf16_f32 v96, v56, v57
  v_cvt_pk_bf16_f32 v97, v58, v59
  v_pk_mul_f32 v[60:61], v[60:61], s[56:57]
  v_pk_mul_f32 v[62:63], v[62:63], s[56:57]
  v_cvt_pk_bf16_f32 v102, v76, v77
  v_cvt_pk_bf16_f32 v103, v78, v79
  v_cvt_pk_bf16_f32 v100, v60, v61
  v_cvt_pk_bf16_f32 v101, v62, v63
  v_pk_mul_f32 v[64:65], v[64:65], s[56:57]
  v_pk_mul_f32 v[66:67], v[66:67], s[56:57]
  v_cvt_pk_bf16_f32 v106, v80, v81
  v_cvt_pk_bf16_f32 v107, v82, v83
  v_cvt_pk_bf16_f32 v104, v64, v65
  v_cvt_pk_bf16_f32 v105, v66, v67
  s_nop 1
  v_permlane16_swap_b32 v92, v96
  v_permlane16_swap_b32 v93, v97
  v_permlane16_swap_b32 v94, v98
  v_permlane16_swap_b32 v95, v99
  v_permlane16_swap_b32 v100, v104
  v_permlane16_swap_b32 v101, v105
  v_permlane16_swap_b32 v102, v106
  v_permlane16_swap_b32 v103, v107
  v_mov_b32 v52, 0
  v_mov_b32 v68, 0
  v_mov_b32 v53, 0
  v_mov_b32 v69, 0
  v_mov_b32 v54, 0
  v_mov_b32 v70, 0
  v_mov_b32 v55, 0
  v_mov_b32 v71, 0
  v_mov_b32 v56, 0
  v_mov_b32 v72, 0
  v_mov_b32 v57, 0
  v_mov_b32 v73, 0
  v_mov_b32 v58, 0
  v_mov_b32 v74, 0
  v_mov_b32 v59, 0
  v_mov_b32 v75, 0
  v_mov_b32 v60, 0
  v_mov_b32 v76, 0
  v_mov_b32 v61, 0
  v_mov_b32 v77, 0
  v_mov_b32 v62, 0
  v_mov_b32 v78, 0
  v_mov_b32 v63, 0
  v_mov_b32 v79, 0
  v_mov_b32 v64, 0
  v_mov_b32 v80, 0
  v_mov_b32 v65, 0
  v_mov_b32 v81, 0
  v_mov_b32 v66, 0
  v_mov_b32 v82, 0
  v_mov_b32 v67, 0
  v_mov_b32 v83, 0
  s_mov_b32 s66, s54
  s_mov_b32 s67, s55
  buffer_store_dwordx4 v[92:95], v108, s[28:31], s66 offen offset:0 sc1
  buffer_store_dwordx4 v[96:99], v108, s[28:31], s67 offen offset:0 sc1
  buffer_store_dwordx4 v[100:103], v108, s[28:31], s66 offen offset:64 sc1
  buffer_store_dwordx4 v[104:107], v108, s[28:31], s67 offen offset:64 sc1
  v_lshrrev_b32 v108, 1, v1
  v_and_b32 v108, 7, v108
  s_lshl_b32 s54, s62, 2
  v_xor_b32 v108, s54, v108
  v_and_b32 v109, 31, v1
  v_lshlrev_b32 v109, 7, v109
  v_lshrrev_b32 v110, 5, v1
  v_lshl_add_u32 v109, v110, 3, v109
  s_mul_i32 s54, s53, 0
  s_lshl_b32 s55, s61, 12
  s_add_u32 s54, s54, s55
  s_add_u32 s54, s54, 16384
  v_add_u32 v109, s54, v109
  v_xor_b32 v110, 0, v108
  v_lshl_add_u32 v110, v110, 4, v109
  ds_read_b64 v[84:85], v110
  v_xor_b32 v110, 1, v108
  v_lshl_add_u32 v110, v110, 4, v109
  ds_read_b64 v[86:87], v110
  v_xor_b32 v110, 2, v108
  v_lshl_add_u32 v110, v110, 4, v109
  ds_read_b64 v[88:89], v110
  v_xor_b32 v110, 3, v108
  v_lshl_add_u32 v110, v110, 4, v109
  ds_read_b64 v[90:91], v110
  s_mov_b32 s68, 0
  s_mov_b32 s60, 0
SPIN_338:
  ds_read_b32 v6, v124 offset:1044
  s_waitcnt lgkmcnt(0)
  v_readfirstlane_b32 s54, v6
  s_cmp_ge_u32 s54, 2
  s_cbranch_scc1 SPD_339
  s_add_u32 s60, s60, 1
  s_cmp_lt_u32 s60, 200000
  s_sleep 1
  s_cbranch_scc1 SPIN_338
  v_mov_b32 v6, 16
  ds_or_b32 v124, v6 offset:1024
SPD_339:
  ds_read_b128 v[16:19], v8 offset:0
  ds_read_b64_tr_b16 v[20:21], v12 offset:0
  ds_read_b64_tr_b16 v[22:23], v12 offset:512
  ds_read_b64_tr_b16 v[24:25], v12 offset:8192
  ds_read_b64_tr_b16 v[26:27], v12 offset:8704
  ds_read_b128 v[28:31], v9 offset:0
  ds_read_b64_tr_b16 v[32:33], v12 offset:2048
  ds_read_b64_tr_b16 v[34:35], v12 offset:2560
  ds_read_b64_tr_b16 v[36:37], v12 offset:10240
  ds_read_b64_tr_b16 v[38:39], v12 offset:10752
  ds_read_b128 v[40:43], v10 offset:0
  ds_read_b64_tr_b16 v[44:45], v12 offset:4096
  ds_read_b64_tr_b16 v[46:47], v12 offset:4608
  ds_read_b64_tr_b16 v[48:49], v12 offset:12288
  ds_read_b64_tr_b16 v[50:51], v12 offset:12800
  s_waitcnt lgkmcnt(10)
  v_mfma_f32_32x32x16_bf16 v[52:67], v[20:23], v[16:19], v[52:67]
  v_mfma_f32_32x32x16_bf16 v[68:83], v[24:27], v[16:19], v[68:83]
  ds_read_b32 v7, v124 offset:1048
  ds_read_b128 v[16:19], v11 offset:0
  ds_read_b64_tr_b16 v[20:21], v12 offset:6144
  ds_read_b64_tr_b16 v[22:23], v12 offset:6656
  ds_read_b64_tr_b16 v[24:25], v12 offset:14336
  ds_read_b64_tr_b16 v[26:27], v12 offset:14848
  s_waitcnt lgkmcnt(10)
  v_mfma_f32_32x32x16_bf16 v[52:67], v[32:35], v[28:31], v[52:67]
  v_mfma_f32_32x32x16_bf16 v[68:83], v[36:39], v[28:31], v[68:83]
  s_waitcnt lgkmcnt(5)
  v_readfirstlane_b32 s54, v7
  s_cmp_ge_u32 s54, 2
  s_cbranch_scc1 RDOK_340
  s_mov_b32 s60, 0
SPIN_341:
  ds_read_b32 v6, v124 offset:1048
  s_waitcnt lgkmcnt(0)
  v_readfirstlane_b32 s54, v6
  s_cmp_ge_u32 s54, 2
  s_cbranch_scc1 SPD_342
  s_add_u32 s60, s60, 1
  s_cmp_lt_u32 s60, 200000
  s_sleep 1
  s_cbranch_scc1 SPIN_341
  v_mov_b32 v6, 16
  ds_or_b32 v124, v6 offset:1024
SPD_342:
RDOK_340:
  ds_read_b128 v[28:31], v8 offset:20480
  ds_read_b64_tr_b16 v[32:33], v12 offset:16384
  ds_read_b64_tr_b16 v[34:35], v12 offset:16896
  ds_read_b64_tr_b16 v[36:37], v12 offset:24576
  ds_read_b64_tr_b16 v[38:39], v12 offset:25088
  s_waitcnt lgkmcnt(10)
  v_mfma_f32_32x32x16_bf16 v[52:67], v[44:47], v[40:43], v[52:67]
  v_mfma_f32_32x32x16_bf16 v[68:83], v[48:51], v[40:43], v[68:83]
  ds_read_b128 v[40:43], v9 offset:20480
  ds_read_b64_tr_b16 v[44:45], v12 offset:18432
  ds_read_b64_tr_b16 v[46:47], v12 offset:18944
  ds_read_b64_tr_b16 v[48:49], v12 offset:26624
  ds_read_b64_tr_b16 v[50:51], v12 offset:27136
  s_waitcnt lgkmcnt(10)
  v_mfma_f32_32x32x16_bf16 v[52:67], v[20:23], v[16:19], v[52:67]
  v_mfma_f32_32x32x16_bf16 v[68:83], v[24:27], v[16:19], v[68:83]
  s_mov_b64 exec, 1
  ds_add_u32 v124, v125 offset:1076
  s_mov_b64 exec, -1
  s_cmp_eq_u32 s68, 0
  s_cbranch_scc0 PH_343
  s_getreg_b32 s54, hwreg(HW_REG_IB_STS, 0, 4)
  s_cmp_eq_u32 s54, 0
  s_cbranch_scc0 PH_343
  s_waitcnt vmcnt(0)
  s_mov_b64 exec, 1
  ds_add_rtn_u32 v6, v124, v125 offset:1092
  s_waitcnt lgkmcnt(0)
  v_readfirstlane_b32 s54, v6
  s_cmp_eq_u32 s54, 9
  s_cbranch_scc0 NLAST_344
  ds_read_b32 v6, v124 offset:1120
  s_lshl_b32 s54, s93, 6
  s_add_u32 s54, s54, s92
  s_lshl_b32 s54, s54, 7
  s_add_u32 s54, s54, 27262976
  s_add_u32 s56, s26, s54
  s_addc_u32 s57, s27, 0
  s_waitcnt lgkmcnt(0)
  global_store_dword v124, v6, s[56:57] sc1
NLAST_344:
  s_mov_b64 exec, -1
  s_mov_b32 s68, 1
PH_343:
  ds_read_b128 v[16:19], v10 offset:20480
  ds_read_b64_tr_b16 v[20:21], v12 offset:20480
  ds_read_b64_tr_b16 v[22:23], v12 offset:20992
  ds_read_b64_tr_b16 v[24:25], v12 offset:28672
  ds_read_b64_tr_b16 v[26:27], v12 offset:29184
  s_waitcnt lgkmcnt(10)
  v_mfma_f32_32x32x16_bf16 v[52:67], v[32:35], v[28:31], v[52:67]
  v_mfma_f32_32x32x16_bf16 v[68:83], v[36:39], v[28:31], v[68:83]
  ds_read_b32 v7, v124 offset:1052
  ds_read_b128 v[28:31], v11 offset:20480
  ds_read_b64_tr_b16 v[32:33], v12 offset:22528
  ds_read_b64_tr_b16 v[34:35], v12 offset:23040
  ds_read_b64_tr_b16 v[36:37], v12 offset:30720
  ds_read_b64_tr_b16 v[38:39], v12 offset:31232
  s_waitcnt lgkmcnt(10)
  v_mfma_f32_32x32x16_bf16 v[52:67], v[44:47], v[40:43], v[52:67]
  v_mfma_f32_32x32x16_bf16 v[68:83], v[48:51], v[40:43], v[68:83]
  s_waitcnt lgkmcnt(5)
  v_readfirstlane_b32 s54, v7
  s_cmp_ge_u32 s54, 2
  s_cbranch_scc1 RDOK_345
  s_mov_b32 s60, 0
SPIN_346:
  ds_read_b32 v6, v124 offset:1052
  s_waitcnt lgkmcnt(0)
  v_readfirstlane_b32 s54, v6
  s_cmp_ge_u32 s54, 2
  s_cbranch_scc1 SPD_347
  s_add_u32 s60, s60, 1
  s_cmp_lt_u32 s60, 200000
  s_sleep 1
  s_cbranch_scc1 SPIN_346
  v_mov_b32 v6, 16
  ds_or_b32 v124, v6 offset:1024
SPD_347:
RDOK_345:
  ds_read_b128 v[40:43], v8 offset:40960
  ds_read_b64_tr_b16 v[44:45], v12 offset:32768
  ds_read_b64_tr_b16 v[46:47], v12 offset:33280
  ds_read_b64_tr_b16 v[48:49], v12 offset:40960
  ds_read_b64_tr_b16 v[50:51], v12 offset:41472
  s_waitcnt lgkmcnt(10)
  v_mfma_f32_32x32x16_bf16 v[52:67], v[20:23], v[16:19], v[52:67]
  v_mfma_f32_32x32x16_bf16 v[68:83], v[24:27], v[16:19], v[68:83]
  ds_read_b128 v[16:19], v9 offset:40960
  ds_read_b64_tr_b16 v[20:21], v12 offset:34816
  ds_read_b64_tr_b16 v[22:23], v12 offset:35328
  ds_read_b64_tr_b16 v[24:25], v12 offset:43008
  ds_read_b64_tr_b16 v[26:27], v12 offset:43520
  s_waitcnt lgkmcnt(10)
  v_mfma_f32_32x32x16_bf16 v[52:67], v[32:35], v[28:31], v[52:67]
  v_mfma_f32_32x32x16_bf16 v[68:83], v[36:39], v[28:31], v[68:83]
  s_mov_b64 exec, 1
  ds_add_u32 v124, v125 offset:1080
  s_mov_b64 exec, -1
  s_cmp_eq_u32 s68, 0
  s_cbranch_scc0 PH_348
  s_getreg_b32 s54, hwreg(HW_REG_IB_STS, 0, 4)
  s_cmp_eq_u32 s54, 0
  s_cbranch_scc0 PH_348
  s_waitcnt vmcnt(0)
  s_mov_b64 exec, 1
  ds_add_rtn_u32 v6, v124, v125 offset:1092
  s_waitcnt lgkmcnt(0)
  v_readfirstlane_b32 s54, v6
  s_cmp_eq_u32 s54, 9
  s_cbranch_scc0 NLAST_349
  ds_read_b32 v6, v124 offset:1120
  s_lshl_b32 s54, s93, 6
  s_add_u32 s54, s54, s92
  s_lshl_b32 s54, s54, 7
  s_add_u32 s54, s54, 27262976
  s_add_u32 s56, s26, s54
  s_addc_u32 s57, s27, 0
  s_waitcnt lgkmcnt(0)
  global_store_dword v124, v6, s[56:57] sc1
NLAST_349:
  s_mov_b64 exec, -1
  s_mov_b32 s68, 1
PH_348:
  ds_read_b128 v[28:31], v10 offset:40960
  ds_read_b64_tr_b16 v[32:33], v12 offset:36864
  ds_read_b64_tr_b16 v[34:35], v12 offset:37376
  ds_read_b64_tr_b16 v[36:37], v12 offset:45056
  ds_read_b64_tr_b16 v[38:39], v12 offset:45568
  s_waitcnt lgkmcnt(10)
  v_mfma_f32_32x32x16_bf16 v[52:67], v[44:47], v[40:43], v[52:67]
  v_mfma_f32_32x32x16_bf16 v[68:83], v[48:51], v[40:43], v[68:83]
  ds_read_b32 v7, v124 offset:1056
  ds_read_b128 v[40:43], v11 offset:40960
  ds_read_b64_tr_b16 v[44:45], v12 offset:38912
  ds_read_b64_tr_b16 v[46:47], v12 offset:39424
  ds_read_b64_tr_b16 v[48:49], v12 offset:47104
  ds_read_b64_tr_b16 v[50:51], v12 offset:47616
  s_waitcnt lgkmcnt(10)
  v_mfma_f32_32x32x16_bf16 v[52:67], v[20:23], v[16:19], v[52:67]
  v_mfma_f32_32x32x16_bf16 v[68:83], v[24:27], v[16:19], v[68:83]
  s_waitcnt lgkmcnt(5)
  v_readfirstlane_b32 s54, v7
  s_cmp_ge_u32 s54, 2
  s_cbranch_scc1 RDOK_350
  s_mov_b32 s60, 0
SPIN_351:
  ds_read_b32 v6, v124 offset:1056
  s_waitcnt lgkmcnt(0)
  v_readfirstlane_b32 s54, v6
  s_cmp_ge_u32 s54, 2
  s_cbranch_scc1 SPD_352
  s_add_u32 s60, s60, 1
  s_cmp_lt_u32 s60, 200000
  s_sleep 1
  s_cbranch_scc1 SPIN_351
  v_mov_b32 v6, 16
  ds_or_b32 v124, v6 offset:1024
SPD_352:
RDOK_350:
  ds_read_b128 v[16:19], v8 offset:61440
  ds_read_b64_tr_b16 v[20:21], v12 offset:49152
  ds_read_b64_tr_b16 v[22:23], v12 offset:49664
  ds_read_b64_tr_b16 v[24:25], v12 offset:57344
  ds_read_b64_tr_b16 v[26:27], v12 offset:57856
  s_waitcnt lgkmcnt(10)
  v_mfma_f32_32x32x16_bf16 v[52:67], v[32:35], v[28:31], v[52:67]
  v_mfma_f32_32x32x16_bf16 v[68:83], v[36:39], v[28:31], v[68:83]
  ds_read_b128 v[28:31], v9 offset:61440
  ds_read_b64_tr_b16 v[32:33], v12 offset:51200
  ds_read_b64_tr_b16 v[34:35], v12 offset:51712
  ds_read_b64_tr_b16 v[36:37], v12 offset:59392
  ds_read_b64_tr_b16 v[38:39], v12 offset:59904
  s_waitcnt lgkmcnt(10)
  v_mfma_f32_32x32x16_bf16 v[52:67], v[44:47], v[40:43], v[52:67]
  v_mfma_f32_32x32x16_bf16 v[68:83], v[48:51], v[40:43], v[68:83]
  s_mov_b64 exec, 1
  ds_add_u32 v124, v125 offset:1084
  s_mov_b64 exec, -1
  s_cmp_eq_u32 s68, 0
  s_cbranch_scc0 PH_353
  s_getreg_b32 s54, hwreg(HW_REG_IB_STS, 0, 4)
  s_cmp_eq_u32 s54, 0
  s_cbranch_scc0 PH_353
  s_waitcnt vmcnt(0)
  s_mov_b64 exec, 1
  ds_add_rtn_u32 v6, v124, v125 offset:1092
  s_waitcnt lgkmcnt(0)
  v_readfirstlane_b32 s54, v6
  s_cmp_eq_u32 s54, 9
  s_cbranch_scc0 NLAST_354
  ds_read_b32 v6, v124 offset:1120
  s_lshl_b32 s54, s93, 6
  s_add_u32 s54, s54, s92
  s_lshl_b32 s54, s54, 7
  s_add_u32 s54, s54, 27262976
  s_add_u32 s56, s26, s54
  s_addc_u32 s57, s27, 0
  s_waitcnt lgkmcnt(0)
  global_store_dword v124, v6, s[56:57] sc1
NLAST_354:
  s_mov_b64 exec, -1
  s_mov_b32 s68, 1
PH_353:
  ds_read_b128 v[40:43], v10 offset:61440
  ds_read_b64_tr_b16 v[44:45], v12 offset:53248
  ds_read_b64_tr_b16 v[46:47], v12 offset:53760
  ds_read_b64_tr_b16 v[48:49], v12 offset:61440
  ds_read_b64_tr_b16 v[50:51], v12 offset:61952
  s_waitcnt lgkmcnt(10)
  v_mfma_f32_32x32x16_bf16 v[52:67], v[20:23], v[16:19], v[52:67]
  v_mfma_f32_32x32x16_bf16 v[68:83], v[24:27], v[16:19], v[68:83]
  ds_read_b128 v[16:19], v11 offset:61440
  ds_read_b64_tr_b16 v[20:21], v12 offset:55296
  ds_read_b64_tr_b16 v[22:23], v12 offset:55808
  ds_read_b64_tr_b16 v[24:25], v12 offset:63488
  ds_read_b64_tr_b16 v[26:27], v12 offset:64000
  s_waitcnt lgkmcnt(10)
  v_mfma_f32_32x32x16_bf16 v[52:67], v[32:35], v[28:31], v[52:67]
  v_mfma_f32_32x32x16_bf16 v[68:83], v[36:39], v[28:31], v[68:83]
  s_waitcnt lgkmcnt(5)
  v_mfma_f32_32x32x16_bf16 v[52:67], v[44:47], v[40:43], v[52:67]
  v_mfma_f32_32x32x16_bf16 v[68:83], v[48:51], v[40:43], v[68:83]
  s_waitcnt lgkmcnt(0)
  v_mfma_f32_32x32x16_bf16 v[52:67], v[20:23], v[16:19], v[52:67]
  v_mfma_f32_32x32x16_bf16 v[68:83], v[24:27], v[16:19], v[68:83]
  s_mov_b64 exec, 1
  ds_add_u32 v124, v125 offset:1088
  s_mov_b64 exec, -1
  s_cmp_eq_u32 s68, 0
  s_cbranch_scc0 PH_355
  s_waitcnt vmcnt(0)
  s_mov_b64 exec, 1
  ds_add_rtn_u32 v6, v124, v125 offset:1092
  s_waitcnt lgkmcnt(0)
  v_readfirstlane_b32 s54, v6
  s_cmp_eq_u32 s54, 9
  s_cbranch_scc0 NLAST_356
  ds_read_b32 v6, v124 offset:1120
  s_lshl_b32 s54, s93, 6
  s_add_u32 s54, s54, s92
  s_lshl_b32 s54, s54, 7
  s_add_u32 s54, s54, 27262976
  s_add_u32 s56, s26, s54
  s_addc_u32 s57, s27, 0
  s_waitcnt lgkmcnt(0)
  global_store_dword v124, v6, s[56:57] sc1
NLAST_356:
  s_mov_b64 exec, -1
  s_mov_b32 s68, 1
PH_355:
  s_lshl_b32 s58, s61, 2
  v_mov_b32 v107, s58
  s_mov_b64 exec, 1
  ds_add_u32 v107, v125 offset:1136
  s_mov_b64 exec, -1
  v_and_b32 v108, 7, v1
  v_lshrrev_b32 v109, 5, v1
  v_xor_b32 v108, v108, v109
  v_and_b32 v109, 31, v1
  v_lshlrev_b32 v109, 7, v109
  s_lshl_b32 s54, s61, 12
  s_mul_i32 s55, s62, 20480
  s_add_u32 s54, s54, s55
  s_add_u32 s54, s54, 16384
  v_add_u32 v109, s54, v109
  s_mov_b32 s56, 0xbfb8aa3b
  s_mov_b32 s57, 0xbfb8aa3b
  v_pk_fma_f32 v[52:53], v[52:53], s[56:57], -1.0 op_sel_hi:[1,1,0]
  v_pk_fma_f32 v[54:55], v[54:55], s[56:57], -1.0 op_sel_hi:[1,1,0]
  v_mov_b32 v16, v84
  v_mov_b32 v17, v85
  v_cvt_pk_bf16_f32 v18, v68, v69
  v_cvt_pk_bf16_f32 v19, v70, v71
  v_xor_b32 v112, 0, v108
  v_lshl_add_u32 v112, v112, 4, v109
  v_pk_fma_f32 v[56:57], v[56:57], s[56:57], -1.0 op_sel_hi:[1,1,0]
  v_pk_fma_f32 v[58:59], v[58:59], s[56:57], -1.0 op_sel_hi:[1,1,0]
  v_mov_b32 v20, v86
  v_mov_b32 v21, v87
  v_cvt_pk_bf16_f32 v22, v72, v73
  v_cvt_pk_bf16_f32 v23, v74, v75
  v_xor_b32 v113, 2, v108
  v_lshl_add_u32 v113, v113, 4, v109
  v_pk_fma_f32 v[60:61], v[60:61], s[56:57], -1.0 op_sel_hi:[1,1,0]
  v_pk_fma_f32 v[62:63], v[62:63], s[56:57], -1.0 op_sel_hi:[1,1,0]
  v_mov_b32 v24, v88
  v_mov_b32 v25, v89
  v_cvt_pk_bf16_f32 v26, v76, v77
  v_cvt_pk_bf16_f32 v27, v78, v79
  v_xor_b32 v114, 4, v108
  v_lshl_add_u32 v114, v114, 4, v109
  v_pk_fma_f32 v[64:65], v[64:65], s[56:57], -1.0 op_sel_hi:[1,1,0]
  v_pk_fma_f32 v[66:67], v[66:67], s[56:57], -1.0 op_sel_hi:[1,1,0]
  v_mov_b32 v28, v90
  v_mov_b32 v29, v91
  v_cvt_pk_bf16_f32 v30, v80, v81
  v_cvt_pk_bf16_f32 v31, v82, v83
  v_xor_b32 v115, 6, v108
  v_lshl_add_u32 v115, v115, 4, v109
  s_mov_b32 s60, 0
XT_357:
  ds_read_b32 v6, v107 offset:1136
  s_waitcnt lgkmcnt(0)
  v_readfirstlane_b32 s59, v6
  s_cmp_ge_u32 s59, 2
  s_cbranch_scc1 XTD_358
  s_add_u32 s60, s60, 1
  s_cmp_lt_u32 s60, 200000
  s_sleep 1
  s_cbranch_scc1 XT_357
XTD_358:
  ds_write_b128 v112, v[52:55]
  ds_write_b128 v112, v[16:19] offset:40960
  ds_write_b128 v113, v[56:59]
  ds_write_b128 v113, v[20:23] offset:40960
  ds_write_b128 v114, v[60:63]
  ds_write_b128 v114, v[24:27] offset:40960
  ds_write_b128 v115, v[64:67]
  ds_write_b128 v115, v[28:31] offset:40960
  s_cmp_eq_u32 s3, 0
  s_cbranch_scc0 NPOLL_359
  ds_read_b32 v7, v124 offset:1120
  s_lshl_b32 s54, s53, 13
  s_add_u32 s54, s54, 27262976
  s_add_u32 s56, s26, s54
  s_addc_u32 s57, s27, 0
  v_lshlrev_b32 v4, 7, v1
  s_mov_b32 s60, 0
  s_waitcnt lgkmcnt(0)
F2P_360:
  global_load_dword v6, v4, s[56:57] sc1
  s_waitcnt vmcnt(0)
  v_cmp_ne_u32 vcc, v6, v7
  s_mov_b64 exec, vcc
  s_cbranch_execz F2D_361
  s_add_u32 s60, s60, 1
  s_cmp_lt_u32 s60, 20000
  s_sleep 4
  s_cbranch_scc1 F2P_360
  s_mov_b64 exec, -1
  v_mov_b32 v6, 16
  ds_or_b32 v124, v6 offset:1024
F2D_361:
  s_mov_b64 exec, -1
  s_mov_b64 exec, 1
  ds_add_u32 v124, v125 offset:1100
  s_mov_b64 exec, -1
NPOLL_359:
BMAIN_216:
  v_and_b32 v47, 15, v1
  v_lshlrev_b32 v4, 3, v47
  s_lshl_b32 s54, s53, 7
  s_add_u32 s16, s16, s54
  s_addc_u32 s17, s17, 0
  global_load_dwordx2 v[104:105], v4, s[16:17]
  s_mul_i32 s55, s53, 2560000
  s_add_u32 s55, s55, 3328
  s_add_u32 s56, s26, s55
  s_addc_u32 s57, s27, 0
  s_mov_b32 s36, s56
  s_and_b32 s37, s57, 0xffff
  s_or_b32 s37, s37, 0x00100000
  s_mov_b32 s38, 64
  s_mov_b32 s39, 0x00800000
  s_mul_i32 s55, s52, 80384
  s_lshl_b32 s56, s53, 7
  s_add_u32 s55, s55, s56
  s_add_u32 s58, s22, s55
  s_addc_u32 s59, s23, 0
  s_sub_u32 s56, 5120000, s55
  s_mov_b32 s40, s58
  s_and_b32 s41, s59, 0xffff
  s_mov_b32 s42, s56
  s_mov_b32 s43, 0x00020000
  s_mul_i32 s55, s52, 157
  s_sub_u32 s55, 10000, s55
  s_min_u32 s90, s55, 157
  s_mov_b32 s86, 0x360637bd
  s_mov_b32 s87, 0x360637bd
  s_mov_b32 s88, 0x35800000
  s_mov_b32 s89, 0x35800000
  v_and_b32 v45, 7, v1
  v_bfe_u32 v54, v1, 3, 1
  v_mul_u32_u24 v54, 20480, v54
  v_add_u32 v54, 16384, v54
  v_lshrrev_b32 v6, 4, v1
  v_lshlrev_b32 v46, 3, v6
  v_and_b32 v4, 3, v1
  v_mov_b32 v40, 0
  v_mov_b32 v41, 0
  v_mov_b32 v42, 0
  v_mov_b32 v43, 0
  v_cmp_eq_u32 vcc, 0, v4
  s_mov_b64 exec, vcc
  v_mov_b32 v40, 0x3f80
  v_mov_b32 v42, 0x4980
  s_mov_b64 exec, -1
  v_cmp_eq_u32 vcc, 1, v4
  s_mov_b64 exec, vcc
  v_mov_b32 v40, 0x3f800000
  v_mov_b32 v42, 0x49800000
  s_mov_b64 exec, -1
  v_cmp_eq_u32 vcc, 2, v4
  s_mov_b64 exec, vcc
  v_mov_b32 v41, 0x3f80
  v_mov_b32 v43, 0x4980
  s_mov_b64 exec, -1
  v_cmp_eq_u32 vcc, 3, v4
  s_mov_b64 exec, vcc
  v_mov_b32 v41, 0x3f800000
  v_mov_b32 v43, 0x49800000
  s_mov_b64 exec, -1
  s_xor_b32 s59, s3, 0
  s_lshr_b32 s54, s59, 2
  s_and_b32 s55, s59, 3
  s_lshr_b32 s56, s54, 1
  s_add_u32 s82, s56, 2
  s_mul_i32 s55, s55, s82
  s_lshl_b32 s56, s54, 3
  s_add_u32 s55, s55, s56
  s_cmp_eq_u32 s54, 3
  s_cselect_b32 s56, 4, 0
  s_add_u32 s55, s55, s56
  s_lshl_b32 s55, s55, 2
  v_mov_b32 v49, 1.0
  v_mov_b32 v50, 0
  v_mov_b32 v51, 0
  v_mov_b32 v52, s55
  s_waitcnt lgkmcnt(0)
  s_barrier
  ds_read_b32 v5, v124 offset:1024
  ds_read_b32 v44, v52 offset:4992
  ds_read_b32 v53, v52 offset:5252
  ds_read_b32 v7, v52 offset:5256
  ds_read_b32 v52, v52 offset:5248
  s_waitcnt lgkmcnt(0)
  v_readfirstlane_b32 s54, v5
  v_readfirstlane_b32 s83, v52
  v_readfirstlane_b32 s84, v53
  v_readfirstlane_b32 s85, v7
  v_lshlrev_b32 v44, 6, v44
  v_lshl_add_u32 v44, v6, 3, v44
  v_add_u32 v44, 98304, v44
  s_min_u32 s83, s83, 39
  s_min_u32 s84, s84, 39
  s_min_u32 s85, s85, 39
  s_lshl_b32 s83, s83, 2
  s_lshl_b32 s84, s84, 2
  s_lshl_b32 s85, s85, 2
  v_lshlrev_b32 v47, 3, v47
  s_cmp_lg_u32 s54, 0
  s_cbranch_scc1 FIN_207
  s_mov_b32 s56, 0xbfb8aa3b
  s_waitcnt vmcnt(0)
  v_lshlrev_b32 v8, 16, v104
  v_and_b32 v9, 0xffff0000, v104
  v_lshlrev_b32 v10, 16, v105
  v_and_b32 v11, 0xffff0000, v105
  v_mul_f32 v8, s56, v8
  v_mul_f32 v9, s56, v9
  v_mul_f32 v10, s56, v10
  v_mul_f32 v11, s56, v11
  s_setprio 1
  s_cmp_eq_u32 s82, 2
  s_cbranch_scc1 PR2_362
  s_setprio 2
PR2_362:
  ds_read2_b64 v[56:59], v44 offset0:0 offset1:4
  ds_read2_b64 v[60:63], v44 offset0:8 offset1:12
  ds_read2_b64 v[64:67], v44 offset0:16 offset1:20
  ds_read2_b64 v[68:71], v44 offset0:24 offset1:28
  s_waitcnt lgkmcnt(0)
  buffer_load_dwordx4 v[72:75], v56, s[36:39], 0 offen sc1
  buffer_load_dwordx4 v[76:79], v58, s[36:39], 0 offen sc1
  buffer_load_dwordx4 v[80:83], v60, s[36:39], 0 offen sc1
  buffer_load_dwordx4 v[84:87], v62, s[36:39], 0 offen sc1
  buffer_load_dwordx4 v[88:91], v64, s[36:39], 0 offen sc1
  buffer_load_dwordx4 v[92:95], v66, s[36:39], 0 offen sc1
  s_call_b64 s[80:81], SETUP_365
  s_waitcnt vmcnt(4)
  v_pk_fma_f32 v[104:105], v[56:57], v[8:9], v[12:13] op_sel:[1,0,0] op_sel_hi:[1,1,1]
  v_pk_fma_f32 v[106:107], v[56:57], v[10:11], v[14:15] op_sel:[1,0,0] op_sel_hi:[1,1,1]
  v_mfma_f32_4x4x4_16b_bf16 v[112:115], v[42:43], v[74:75], 0
  s_nop 0
  v_mfma_f32_4x4x4_16b_bf16 v[104:107], v[40:41], v[72:73], v[104:107]
  s_nop 4
  s_cmp_eq_u64 s[72:73], -1
  s_cbranch_scc1 AF_366
  s_branch AM_370
AF_366:
  s_waitcnt lgkmcnt(0)
  buffer_load_dwordx4 v[96:99], v68, s[36:39], 0 offen sc1
  buffer_load_dwordx4 v[100:103], v70, s[36:39], 0 offen sc1
  v_pk_fma_f32 v[108:109], v[58:59], v[8:9], v[12:13] op_sel:[1,0,0] op_sel_hi:[1,1,1]
  v_pk_fma_f32 v[110:111], v[58:59], v[10:11], v[14:15] op_sel:[1,0,0] op_sel_hi:[1,1,1]
  v_mfma_f32_4x4x4_16b_bf16 v[116:119], v[42:43], v[78:79], 0
  v_exp_f32 v104, v104
  v_exp_f32 v105, v105
  v_mfma_f32_4x4x4_16b_bf16 v[108:111], v[40:41], v[76:77], v[108:111]
  v_exp_f32 v106, v106
  v_exp_f32 v107, v107
  ds_read2_b64 v[56:59], v44 offset0:32 offset1:36
  v_pk_mul_f32 v[120:121], v[112:113], v[28:29]
  v_pk_mul_f32 v[122:123], v[114:115], v[30:31]
  v_pk_fma_f32 v[104:105], v[16:17], 0.5, v[104:105] op_sel_hi:[1,0,1]
  v_pk_fma_f32 v[106:107], v[18:19], 0.5, v[106:107] op_sel_hi:[1,0,1]
  v_pk_fma_f32 v[20:21], v[20:21], v[104:105], v[28:29]
  v_pk_fma_f32 v[22:23], v[22:23], v[106:107], v[30:31]
  v_pk_fma_f32 v[24:25], v[24:25], v[104:105], v[120:121]
  v_pk_fma_f32 v[26:27], v[26:27], v[106:107], v[122:123]
  v_pk_mul_f32 v[28:29], v[28:29], v[104:105]
  v_pk_mul_f32 v[30:31], v[30:31], v[106:107]
  s_sub_u32 s74, s74, 1
  s_cbranch_scc1 EA_382
BF_374:
  s_waitcnt vmcnt(4)
  v_pk_fma_f32 v[104:105], v[60:61], v[8:9], v[12:13] op_sel:[1,0,0] op_sel_hi:[1,1,1]
  v_pk_fma_f32 v[106:107], v[60:61], v[10:11], v[14:15] op_sel:[1,0,0] op_sel_hi:[1,1,1]
  v_mfma_f32_4x4x4_16b_bf16 v[112:115], v[42:43], v[82:83], 0
  v_exp_f32 v108, v108
  v_exp_f32 v109, v109
  v_mfma_f32_4x4x4_16b_bf16 v[104:107], v[40:41], v[80:81], v[104:107]
  v_exp_f32 v110, v110
  v_exp_f32 v111, v111
  v_pk_mul_f32 v[120:121], v[116:117], v[28:29]
  v_pk_mul_f32 v[122:123], v[118:119], v[30:31]
  v_pk_fma_f32 v[108:109], v[16:17], 0.5, v[108:109] op_sel_hi:[1,0,1]
  v_pk_fma_f32 v[110:111], v[18:19], 0.5, v[110:111] op_sel_hi:[1,0,1]
  v_pk_fma_f32 v[20:21], v[20:21], v[108:109], v[28:29]
  v_pk_fma_f32 v[22:23], v[22:23], v[110:111], v[30:31]
  v_pk_fma_f32 v[24:25], v[24:25], v[108:109], v[120:121]
  v_pk_fma_f32 v[26:27], v[26:27], v[110:111], v[122:123]
  v_pk_mul_f32 v[28:29], v[28:29], v[108:109]
  v_pk_mul_f32 v[30:31], v[30:31], v[110:111]
  s_sub_u32 s74, s74, 1
  s_cbranch_scc1 EB_383
AF_367:
  s_waitcnt lgkmcnt(0)
  buffer_load_dwordx4 v[72:75], v56, s[36:39], 0 offen sc1
  buffer_load_dwordx4 v[76:79], v58, s[36:39], 0 offen sc1
  v_pk_fma_f32 v[108:109], v[62:63], v[8:9], v[12:13] op_sel:[1,0,0] op_sel_hi:[1,1,1]
  v_pk_fma_f32 v[110:111], v[62:63], v[10:11], v[14:15] op_sel:[1,0,0] op_sel_hi:[1,1,1]
  v_mfma_f32_4x4x4_16b_bf16 v[116:119], v[42:43], v[86:87], 0
  v_exp_f32 v104, v104
  v_exp_f32 v105, v105
  v_mfma_f32_4x4x4_16b_bf16 v[108:111], v[40:41], v[84:85], v[108:111]
  v_exp_f32 v106, v106
  v_exp_f32 v107, v107
  ds_read2_b64 v[60:63], v44 offset0:40 offset1:44
  v_pk_mul_f32 v[120:121], v[112:113], v[28:29]
  v_pk_mul_f32 v[122:123], v[114:115], v[30:31]
  v_pk_fma_f32 v[104:105], v[16:17], 0.5, v[104:105] op_sel_hi:[1,0,1]
  v_pk_fma_f32 v[106:107], v[18:19], 0.5, v[106:107] op_sel_hi:[1,0,1]
  v_pk_fma_f32 v[20:21], v[20:21], v[104:105], v[28:29]
  v_pk_fma_f32 v[22:23], v[22:23], v[106:107], v[30:31]
  v_pk_fma_f32 v[24:25], v[24:25], v[104:105], v[120:121]
  v_pk_fma_f32 v[26:27], v[26:27], v[106:107], v[122:123]
  v_pk_mul_f32 v[28:29], v[28:29], v[104:105]
  v_pk_mul_f32 v[30:31], v[30:31], v[106:107]
  s_sub_u32 s74, s74, 1
  s_cbranch_scc1 EA_384
BF_375:
  s_waitcnt vmcnt(4)
  v_pk_fma_f32 v[104:105], v[64:65], v[8:9], v[12:13] op_sel:[1,0,0] op_sel_hi:[1,1,1]
  v_pk_fma_f32 v[106:107], v[64:65], v[10:11], v[14:15] op_sel:[1,0,0] op_sel_hi:[1,1,1]
  v_mfma_f32_4x4x4_16b_bf16 v[112:115], v[42:43], v[90:91], 0
  v_exp_f32 v108, v108
  v_exp_f32 v109, v109
  v_mfma_f32_4x4x4_16b_bf16 v[104:107], v[40:41], v[88:89], v[104:107]
  v_exp_f32 v110, v110
  v_exp_f32 v111, v111
  v_pk_mul_f32 v[120:121], v[116:117], v[28:29]
  v_pk_mul_f32 v[122:123], v[118:119], v[30:31]
  v_pk_fma_f32 v[108:109], v[16:17], 0.5, v[108:109] op_sel_hi:[1,0,1]
  v_pk_fma_f32 v[110:111], v[18:19], 0.5, v[110:111] op_sel_hi:[1,0,1]
  v_pk_fma_f32 v[20:21], v[20:21], v[108:109], v[28:29]
  v_pk_fma_f32 v[22:23], v[22:23], v[110:111], v[30:31]
  v_pk_fma_f32 v[24:25], v[24:25], v[108:109], v[120:121]
  v_pk_fma_f32 v[26:27], v[26:27], v[110:111], v[122:123]
  v_pk_mul_f32 v[28:29], v[28:29], v[108:109]
  v_pk_mul_f32 v[30:31], v[30:31], v[110:111]
  s_sub_u32 s74, s74, 1
  s_cbranch_scc1 EB_385
AF_368:
  s_waitcnt lgkmcnt(0)
  buffer_load_dwordx4 v[80:83], v60, s[36:39], 0 offen sc1
  buffer_load_dwordx4 v[84:87], v62, s[36:39], 0 offen sc1
  v_pk_fma_f32 v[108:109], v[66:67], v[8:9], v[12:13] op_sel:[1,0,0] op_sel_hi:[1,1,1]
  v_pk_fma_f32 v[110:111], v[66:67], v[10:11], v[14:15] op_sel:[1,0,0] op_sel_hi:[1,1,1]
  v_mfma_f32_4x4x4_16b_bf16 v[116:119], v[42:43], v[94:95], 0
  v_exp_f32 v104, v104
  v_exp_f32 v105, v105
  v_mfma_f32_4x4x4_16b_bf16 v[108:111], v[40:41], v[92:93], v[108:111]
  v_exp_f32 v106, v106
  v_exp_f32 v107, v107
  ds_read2_b64 v[64:67], v44 offset0:48 offset1:52
  v_pk_mul_f32 v[120:121], v[112:113], v[28:29]
  v_pk_mul_f32 v[122:123], v[114:115], v[30:31]
  v_pk_fma_f32 v[104:105], v[16:17], 0.5, v[104:105] op_sel_hi:[1,0,1]
  v_pk_fma_f32 v[106:107], v[18:19], 0.5, v[106:107] op_sel_hi:[1,0,1]
  v_pk_fma_f32 v[20:21], v[20:21], v[104:105], v[28:29]
  v_pk_fma_f32 v[22:23], v[22:23], v[106:107], v[30:31]
  v_pk_fma_f32 v[24:25], v[24:25], v[104:105], v[120:121]
  v_pk_fma_f32 v[26:27], v[26:27], v[106:107], v[122:123]
  v_pk_mul_f32 v[28:29], v[28:29], v[104:105]
  v_pk_mul_f32 v[30:31], v[30:31], v[106:107]
  s_sub_u32 s74, s74, 1
  s_cbranch_scc1 EA_386
BF_376:
  s_waitcnt vmcnt(4)
  v_pk_fma_f32 v[104:105], v[68:69], v[8:9], v[12:13] op_sel:[1,0,0] op_sel_hi:[1,1,1]
  v_pk_fma_f32 v[106:107], v[68:69], v[10:11], v[14:15] op_sel:[1,0,0] op_sel_hi:[1,1,1]
  v_mfma_f32_4x4x4_16b_bf16 v[112:115], v[42:43], v[98:99], 0
  v_exp_f32 v108, v108
  v_exp_f32 v109, v109
  v_mfma_f32_4x4x4_16b_bf16 v[104:107], v[40:41], v[96:97], v[104:107]
  v_exp_f32 v110, v110
  v_exp_f32 v111, v111
  v_pk_mul_f32 v[120:121], v[116:117], v[28:29]
  v_pk_mul_f32 v[122:123], v[118:119], v[30:31]
  v_pk_fma_f32 v[108:109], v[16:17], 0.5, v[108:109] op_sel_hi:[1,0,1]
  v_pk_fma_f32 v[110:111], v[18:19], 0.5, v[110:111] op_sel_hi:[1,0,1]
  v_pk_fma_f32 v[20:21], v[20:21], v[108:109], v[28:29]
  v_pk_fma_f32 v[22:23], v[22:23], v[110:111], v[30:31]
  v_pk_fma_f32 v[24:25], v[24:25], v[108:109], v[120:121]
  v_pk_fma_f32 v[26:27], v[26:27], v[110:111], v[122:123]
  v_pk_mul_f32 v[28:29], v[28:29], v[108:109]
  v_pk_mul_f32 v[30:31], v[30:31], v[110:111]
  s_sub_u32 s74, s74, 1
  s_cbranch_scc1 EB_387
AF_369:
  s_waitcnt lgkmcnt(0)
  buffer_load_dwordx4 v[88:91], v64, s[36:39], 0 offen sc1
  buffer_load_dwordx4 v[92:95], v66, s[36:39], 0 offen sc1
  v_pk_fma_f32 v[108:109], v[70:71], v[8:9], v[12:13] op_sel:[1,0,0] op_sel_hi:[1,1,1]
  v_pk_fma_f32 v[110:111], v[70:71], v[10:11], v[14:15] op_sel:[1,0,0] op_sel_hi:[1,1,1]
  v_mfma_f32_4x4x4_16b_bf16 v[116:119], v[42:43], v[102:103], 0
  v_exp_f32 v104, v104
  v_exp_f32 v105, v105
  v_mfma_f32_4x4x4_16b_bf16 v[108:111], v[40:41], v[100:101], v[108:111]
  v_exp_f32 v106, v106
  v_exp_f32 v107, v107
  ds_read2_b64 v[68:71], v44 offset0:56 offset1:60
  v_add_u32 v44, 256, v44
  v_pk_mul_f32 v[120:121], v[112:113], v[28:29]
  v_pk_mul_f32 v[122:123], v[114:115], v[30:31]
  v_pk_fma_f32 v[104:105], v[16:17], 0.5, v[104:105] op_sel_hi:[1,0,1]
  v_pk_fma_f32 v[106:107], v[18:19], 0.5, v[106:107] op_sel_hi:[1,0,1]
  v_pk_fma_f32 v[20:21], v[20:21], v[104:105], v[28:29]
  v_pk_fma_f32 v[22:23], v[22:23], v[106:107], v[30:31]
  v_pk_fma_f32 v[24:25], v[24:25], v[104:105], v[120:121]
  v_pk_fma_f32 v[26:27], v[26:27], v[106:107], v[122:123]
  v_pk_mul_f32 v[28:29], v[28:29], v[104:105]
  v_pk_mul_f32 v[30:31], v[30:31], v[106:107]
  s_sub_u32 s74, s74, 1
  s_cbranch_scc1 EA_388
BF_377:
  s_waitcnt vmcnt(4)
  v_pk_fma_f32 v[104:105], v[56:57], v[8:9], v[12:13] op_sel:[1,0,0] op_sel_hi:[1,1,1]
  v_pk_fma_f32 v[106:107], v[56:57], v[10:11], v[14:15] op_sel:[1,0,0] op_sel_hi:[1,1,1]
  v_mfma_f32_4x4x4_16b_bf16 v[112:115], v[42:43], v[74:75], 0
  v_exp_f32 v108, v108
  v_exp_f32 v109, v109
  v_mfma_f32_4x4x4_16b_bf16 v[104:107], v[40:41], v[72:73], v[104:107]
  v_exp_f32 v110, v110
  v_exp_f32 v111, v111
  v_pk_mul_f32 v[120:121], v[116:117], v[28:29]
  v_pk_mul_f32 v[122:123], v[118:119], v[30:31]
  v_pk_fma_f32 v[108:109], v[16:17], 0.5, v[108:109] op_sel_hi:[1,0,1]
  v_pk_fma_f32 v[110:111], v[18:19], 0.5, v[110:111] op_sel_hi:[1,0,1]
  v_pk_fma_f32 v[20:21], v[20:21], v[108:109], v[28:29]
  v_pk_fma_f32 v[22:23], v[22:23], v[110:111], v[30:31]
  v_pk_fma_f32 v[24:25], v[24:25], v[108:109], v[120:121]
  v_pk_fma_f32 v[26:27], v[26:27], v[110:111], v[122:123]
  v_pk_mul_f32 v[28:29], v[28:29], v[108:109]
  v_pk_mul_f32 v[30:31], v[30:31], v[110:111]
  s_sub_u32 s74, s74, 1
  s_cbranch_scc1 EB_389
  s_branch AF_366
AM_370:
  s_waitcnt lgkmcnt(0)
  buffer_load_dwordx4 v[96:99], v68, s[36:39], 0 offen sc1
  buffer_load_dwordx4 v[100:103], v70, s[36:39], 0 offen sc1
  v_pk_fma_f32 v[108:109], v[58:59], v[8:9], v[12:13] op_sel:[1,0,0] op_sel_hi:[1,1,1]
  v_pk_fma_f32 v[110:111], v[58:59], v[10:11], v[14:15] op_sel:[1,0,0] op_sel_hi:[1,1,1]
  v_mfma_f32_4x4x4_16b_bf16 v[116:119], v[42:43], v[78:79], 0
  v_exp_f32 v104, v104
  v_exp_f32 v105, v105
  v_mfma_f32_4x4x4_16b_bf16 v[108:111], v[40:41], v[76:77], v[108:111]
  v_exp_f32 v106, v106
  v_exp_f32 v107, v107
  ds_read2_b64 v[56:59], v44 offset0:32 offset1:36
  v_pk_mul_f32 v[120:121], v[112:113], v[28:29]
  v_pk_mul_f32 v[122:123], v[114:115], v[30:31]
  v_pk_fma_f32 v[104:105], v[16:17], 0.5, v[104:105] op_sel_hi:[1,0,1]
  v_pk_fma_f32 v[106:107], v[18:19], 0.5, v[106:107] op_sel_hi:[1,0,1]
  s_mov_b64 exec, s[72:73]
  v_pk_fma_f32 v[20:21], v[20:21], v[104:105], v[28:29]
  v_pk_fma_f32 v[22:23], v[22:23], v[106:107], v[30:31]
  v_pk_fma_f32 v[24:25], v[24:25], v[104:105], v[120:121]
  v_pk_fma_f32 v[26:27], v[26:27], v[106:107], v[122:123]
  v_pk_mul_f32 v[28:29], v[28:29], v[104:105]
  v_pk_mul_f32 v[30:31], v[30:31], v[106:107]
  s_mov_b64 exec, -1
  s_sub_u32 s74, s74, 1
  s_cbranch_scc1 EA_390
BM_378:
  s_waitcnt vmcnt(4)
  v_pk_fma_f32 v[104:105], v[60:61], v[8:9], v[12:13] op_sel:[1,0,0] op_sel_hi:[1,1,1]
  v_pk_fma_f32 v[106:107], v[60:61], v[10:11], v[14:15] op_sel:[1,0,0] op_sel_hi:[1,1,1]
  v_mfma_f32_4x4x4_16b_bf16 v[112:115], v[42:43], v[82:83], 0
  v_exp_f32 v108, v108
  v_exp_f32 v109, v109
  v_mfma_f32_4x4x4_16b_bf16 v[104:107], v[40:41], v[80:81], v[104:107]
  v_exp_f32 v110, v110
  v_exp_f32 v111, v111
  v_pk_mul_f32 v[120:121], v[116:117], v[28:29]
  v_pk_mul_f32 v[122:123], v[118:119], v[30:31]
  v_pk_fma_f32 v[108:109], v[16:17], 0.5, v[108:109] op_sel_hi:[1,0,1]
  v_pk_fma_f32 v[110:111], v[18:19], 0.5, v[110:111] op_sel_hi:[1,0,1]
  s_mov_b64 exec, s[72:73]
  v_pk_fma_f32 v[20:21], v[20:21], v[108:109], v[28:29]
  v_pk_fma_f32 v[22:23], v[22:23], v[110:111], v[30:31]
  v_pk_fma_f32 v[24:25], v[24:25], v[108:109], v[120:121]
  v_pk_fma_f32 v[26:27], v[26:27], v[110:111], v[122:123]
  v_pk_mul_f32 v[28:29], v[28:29], v[108:109]
  v_pk_mul_f32 v[30:31], v[30:31], v[110:111]
  s_mov_b64 exec, -1
  s_sub_u32 s74, s74, 1
  s_cbranch_scc1 EB_391
AM_371:
  s_waitcnt lgkmcnt(0)
  buffer_load_dwordx4 v[72:75], v56, s[36:39], 0 offen sc1
  buffer_load_dwordx4 v[76:79], v58, s[36:39], 0 offen sc1
  v_pk_fma_f32 v[108:109], v[62:63], v[8:9], v[12:13] op_sel:[1,0,0] op_sel_hi:[1,1,1]
  v_pk_fma_f32 v[110:111], v[62:63], v[10:11], v[14:15] op_sel:[1,0,0] op_sel_hi:[1,1,1]
  v_mfma_f32_4x4x4_16b_bf16 v[116:119], v[42:43], v[86:87], 0
  v_exp_f32 v104, v104
  v_exp_f32 v105, v105
  v_mfma_f32_4x4x4_16b_bf16 v[108:111], v[40:41], v[84:85], v[108:111]
  v_exp_f32 v106, v106
  v_exp_f32 v107, v107
  ds_read2_b64 v[60:63], v44 offset0:40 offset1:44
  v_pk_mul_f32 v[120:121], v[112:113], v[28:29]
  v_pk_mul_f32 v[122:123], v[114:115], v[30:31]
  v_pk_fma_f32 v[104:105], v[16:17], 0.5, v[104:105] op_sel_hi:[1,0,1]
  v_pk_fma_f32 v[106:107], v[18:19], 0.5, v[106:107] op_sel_hi:[1,0,1]
  s_mov_b64 exec, s[72:73]
  v_pk_fma_f32 v[20:21], v[20:21], v[104:105], v[28:29]
  v_pk_fma_f32 v[22:23], v[22:23], v[106:107], v[30:31]
  v_pk_fma_f32 v[24:25], v[24:25], v[104:105], v[120:121]
  v_pk_fma_f32 v[26:27], v[26:27], v[106:107], v[122:123]
  v_pk_mul_f32 v[28:29], v[28:29], v[104:105]
  v_pk_mul_f32 v[30:31], v[30:31], v[106:107]
  s_mov_b64 exec, -1
  s_sub_u32 s74, s74, 1
  s_cbranch_scc1 EA_392
BM_379:
  s_waitcnt vmcnt(4)
  v_pk_fma_f32 v[104:105], v[64:65], v[8:9], v[12:13] op_sel:[1,0,0] op_sel_hi:[1,1,1]
  v_pk_fma_f32 v[106:107], v[64:65], v[10:11], v[14:15] op_sel:[1,0,0] op_sel_hi:[1,1,1]
  v_mfma_f32_4x4x4_16b_bf16 v[112:115], v[42:43], v[90:91], 0
  v_exp_f32 v108, v108
  v_exp_f32 v109, v109
  v_mfma_f32_4x4x4_16b_bf16 v[104:107], v[40:41], v[88:89], v[104:107]
  v_exp_f32 v110, v110
  v_exp_f32 v111, v111
  v_pk_mul_f32 v[120:121], v[116:117], v[28:29]
  v_pk_mul_f32 v[122:123], v[118:119], v[30:31]
  v_pk_fma_f32 v[108:109], v[16:17], 0.5, v[108:109] op_sel_hi:[1,0,1]
  v_pk_fma_f32 v[110:111], v[18:19], 0.5, v[110:111] op_sel_hi:[1,0,1]
  s_mov_b64 exec, s[72:73]
  v_pk_fma_f32 v[20:21], v[20:21], v[108:109], v[28:29]
  v_pk_fma_f32 v[22:23], v[22:23], v[110:111], v[30:31]
  v_pk_fma_f32 v[24:25], v[24:25], v[108:109], v[120:121]
  v_pk_fma_f32 v[26:27], v[26:27], v[110:111], v[122:123]
  v_pk_mul_f32 v[28:29], v[28:29], v[108:109]
  v_pk_mul_f32 v[30:31], v[30:31], v[110:111]
  s_mov_b64 exec, -1
  s_sub_u32 s74, s74, 1
  s_cbranch_scc1 EB_393
AM_372:
  s_waitcnt lgkmcnt(0)
  buffer_load_dwordx4 v[80:83], v60, s[36:39], 0 offen sc1
  buffer_load_dwordx4 v[84:87], v62, s[36:39], 0 offen sc1
  v_pk_fma_f32 v[108:109], v[66:67], v[8:9], v[12:13] op_sel:[1,0,0] op_sel_hi:[1,1,1]
  v_pk_fma_f32 v[110:111], v[66:67], v[10:11], v[14:15] op_sel:[1,0,0] op_sel_hi:[1,1,1]
  v_mfma_f32_4x4x4_16b_bf16 v[116:119], v[42:43], v[94:95], 0
  v_exp_f32 v104, v104
  v_exp_f32 v105, v105
  v_mfma_f32_4x4x4_16b_bf16 v[108:111], v[40:41], v[92:93], v[108:111]
  v_exp_f32 v106, v106
  v_exp_f32 v107, v107
  ds_read2_b64 v[64:67], v44 offset0:48 offset1:52
  v_pk_mul_f32 v[120:121], v[112:113], v[28:29]
  v_pk_mul_f32 v[122:123], v[114:115], v[30:31]
  v_pk_fma_f32 v[104:105], v[16:17], 0.5, v[104:105] op_sel_hi:[1,0,1]
  v_pk_fma_f32 v[106:107], v[18:19], 0.5, v[106:107] op_sel_hi:[1,0,1]
  s_mov_b64 exec, s[72:73]
  v_pk_fma_f32 v[20:21], v[20:21], v[104:105], v[28:29]
  v_pk_fma_f32 v[22:23], v[22:23], v[106:107], v[30:31]
  v_pk_fma_f32 v[24:25], v[24:25], v[104:105], v[120:121]
  v_pk_fma_f32 v[26:27], v[26:27], v[106:107], v[122:123]
  v_pk_mul_f32 v[28:29], v[28:29], v[104:105]
  v_pk_mul_f32 v[30:31], v[30:31], v[106:107]
  s_mov_b64 exec, -1
  s_sub_u32 s74, s74, 1
  s_cbranch_scc1 EA_394
BM_380:
  s_waitcnt vmcnt(4)
  v_pk_fma_f32 v[104:105], v[68:69], v[8:9], v[12:13] op_sel:[1,0,0] op_sel_hi:[1,1,1]
  v_pk_fma_f32 v[106:107], v[68:69], v[10:11], v[14:15] op_sel:[1,0,0] op_sel_hi:[1,1,1]
  v_mfma_f32_4x4x4_16b_bf16 v[112:115], v[42:43], v[98:99], 0
  v_exp_f32 v108, v108
  v_exp_f32 v109, v109
  v_mfma_f32_4x4x4_16b_bf16 v[104:107], v[40:41], v[96:97], v[104:107]
  v_exp_f32 v110, v110
  v_exp_f32 v111, v111
  v_pk_mul_f32 v[120:121], v[116:117], v[28:29]
  v_pk_mul_f32 v[122:123], v[118:119], v[30:31]
  v_pk_fma_f32 v[108:109], v[16:17], 0.5, v[108:109] op_sel_hi:[1,0,1]
  v_pk_fma_f32 v[110:111], v[18:19], 0.5, v[110:111] op_sel_hi:[1,0,1]
  s_mov_b64 exec, s[72:73]
  v_pk_fma_f32 v[20:21], v[20:21], v[108:109], v[28:29]
  v_pk_fma_f32 v[22:23], v[22:23], v[110:111], v[30:31]
  v_pk_fma_f32 v[24:25], v[24:25], v[108:109], v[120:121]
  v_pk_fma_f32 v[26:27], v[26:27], v[110:111], v[122:123]
  v_pk_mul_f32 v[28:29], v[28:29], v[108:109]
  v_pk_mul_f32 v[30:31], v[30:31], v[110:111]
  s_mov_b64 exec, -1
  s_sub_u32 s74, s74, 1
  s_cbranch_scc1 EB_395
AM_373:
  s_waitcnt lgkmcnt(0)
  buffer_load_dwordx4 v[88:91], v64, s[36:39], 0 offen sc1
  buffer_load_dwordx4 v[92:95], v66, s[36:39], 0 offen sc1
  v_pk_fma_f32 v[108:109], v[70:71], v[8:9], v[12:13] op_sel:[1,0,0] op_sel_hi:[1,1,1]
  v_pk_fma_f32 v[110:111], v[70:71], v[10:11], v[14:15] op_sel:[1,0,0] op_sel_hi:[1,1,1]
  v_mfma_f32_4x4x4_16b_bf16 v[116:119], v[42:43], v[102:103], 0
  v_exp_f32 v104, v104
  v_exp_f32 v105, v105
  v_mfma_f32_4x4x4_16b_bf16 v[108:111], v[40:41], v[100:101], v[108:111]
  v_exp_f32 v106, v106
  v_exp_f32 v107, v107
  ds_read2_b64 v[68:71], v44 offset0:56 offset1:60
  v_add_u32 v44, 256, v44
  v_pk_mul_f32 v[120:121], v[112:113], v[28:29]
  v_pk_mul_f32 v[122:123], v[114:115], v[30:31]
  v_pk_fma_f32 v[104:105], v[16:17], 0.5, v[104:105] op_sel_hi:[1,0,1]
  v_pk_fma_f32 v[106:107], v[18:19], 0.5, v[106:107] op_sel_hi:[1,0,1]
  s_mov_b64 exec, s[72:73]
  v_pk_fma_f32 v[20:21], v[20:21], v[104:105], v[28:29]
  v_pk_fma_f32 v[22:23], v[22:23], v[106:107], v[30:31]
  v_pk_fma_f32 v[24:25], v[24:25], v[104:105], v[120:121]
  v_pk_fma_f32 v[26:27], v[26:27], v[106:107], v[122:123]
  v_pk_mul_f32 v[28:29], v[28:29], v[104:105]
  v_pk_mul_f32 v[30:31], v[30:31], v[106:107]
  s_mov_b64 exec, -1
  s_sub_u32 s74, s74, 1
  s_cbranch_scc1 EA_396
BM_381:
  s_waitcnt vmcnt(4)
  v_pk_fma_f32 v[104:105], v[56:57], v[8:9], v[12:13] op_sel:[1,0,0] op_sel_hi:[1,1,1]
  v_pk_fma_f32 v[106:107], v[56:57], v[10:11], v[14:15] op_sel:[1,0,0] op_sel_hi:[1,1,1]
  v_mfma_f32_4x4x4_16b_bf16 v[112:115], v[42:43], v[74:75], 0
  v_exp_f32 v108, v108
  v_exp_f32 v109, v109
  v_mfma_f32_4x4x4_16b_bf16 v[104:107], v[40:41], v[72:73], v[104:107]
  v_exp_f32 v110, v110
  v_exp_f32 v111, v111
  v_pk_mul_f32 v[120:121], v[116:117], v[28:29]
  v_pk_mul_f32 v[122:123], v[118:119], v[30:31]
  v_pk_fma_f32 v[108:109], v[16:17], 0.5, v[108:109] op_sel_hi:[1,0,1]
  v_pk_fma_f32 v[110:111], v[18:19], 0.5, v[110:111] op_sel_hi:[1,0,1]
  s_mov_b64 exec, s[72:73]
  v_pk_fma_f32 v[20:21], v[20:21], v[108:109], v[28:29]
  v_pk_fma_f32 v[22:23], v[22:23], v[110:111], v[30:31]
  v_pk_fma_f32 v[24:25], v[24:25], v[108:109], v[120:121]
  v_pk_fma_f32 v[26:27], v[26:27], v[110:111], v[122:123]
  v_pk_mul_f32 v[28:29], v[28:29], v[108:109]
  v_pk_mul_f32 v[30:31], v[30:31], v[110:111]
  s_mov_b64 exec, -1
  s_sub_u32 s74, s74, 1
  s_cbranch_scc1 EB_397
  s_branch AM_370
EA_382:
  s_call_b64 s[80:81], EVH_364
  s_cmp_eq_u32 s79, 0
  s_cbranch_scc1 BM_378
  s_waitcnt vmcnt(4)
  v_pk_fma_f32 v[104:105], v[60:61], v[8:9], v[12:13] op_sel:[1,0,0] op_sel_hi:[1,1,1]
  v_pk_fma_f32 v[106:107], v[60:61], v[10:11], v[14:15] op_sel:[1,0,0] op_sel_hi:[1,1,1]
  v_mfma_f32_4x4x4_16b_bf16 v[112:115], v[42:43], v[82:83], 0
  s_nop 0
  v_mfma_f32_4x4x4_16b_bf16 v[104:107], v[40:41], v[80:81], v[104:107]
  s_nop 4
  s_cmp_eq_u64 s[72:73], -1
  s_cbranch_scc1 AF_367
  s_branch AM_371
EB_383:
  s_call_b64 s[80:81], EVH_364
  s_cmp_eq_u32 s79, 0
  s_cbranch_scc1 AM_371
  v_pk_fma_f32 v[104:105], v[60:61], v[8:9], v[12:13] op_sel:[1,0,0] op_sel_hi:[1,1,1]
  v_pk_fma_f32 v[106:107], v[60:61], v[10:11], v[14:15] op_sel:[1,0,0] op_sel_hi:[1,1,1]
  v_mfma_f32_4x4x4_16b_bf16 v[112:115], v[42:43], v[82:83], 0
  s_nop 0
  v_mfma_f32_4x4x4_16b_bf16 v[104:107], v[40:41], v[80:81], v[104:107]
  s_nop 4
  s_cmp_eq_u64 s[72:73], -1
  s_cbranch_scc1 AF_367
  s_branch AM_371
EA_384:
  s_call_b64 s[80:81], EVH_364
  s_cmp_eq_u32 s79, 0
  s_cbranch_scc1 BM_379
  s_waitcnt vmcnt(4)
  v_pk_fma_f32 v[104:105], v[64:65], v[8:9], v[12:13] op_sel:[1,0,0] op_sel_hi:[1,1,1]
  v_pk_fma_f32 v[106:107], v[64:65], v[10:11], v[14:15] op_sel:[1,0,0] op_sel_hi:[1,1,1]
  v_mfma_f32_4x4x4_16b_bf16 v[112:115], v[42:43], v[90:91], 0
  s_nop 0
  v_mfma_f32_4x4x4_16b_bf16 v[104:107], v[40:41], v[88:89], v[104:107]
  s_nop 4
  s_cmp_eq_u64 s[72:73], -1
  s_cbranch_scc1 AF_368
  s_branch AM_372
EB_385:
  s_call_b64 s[80:81], EVH_364
  s_cmp_eq_u32 s79, 0
  s_cbranch_scc1 AM_372
  v_pk_fma_f32 v[104:105], v[64:65], v[8:9], v[12:13] op_sel:[1,0,0] op_sel_hi:[1,1,1]
  v_pk_fma_f32 v[106:107], v[64:65], v[10:11], v[14:15] op_sel:[1,0,0] op_sel_hi:[1,1,1]
  v_mfma_f32_4x4x4_16b_bf16 v[112:115], v[42:43], v[90:91], 0
  s_nop 0
  v_mfma_f32_4x4x4_16b_bf16 v[104:107], v[40:41], v[88:89], v[104:107]
  s_nop 4
  s_cmp_eq_u64 s[72:73], -1
  s_cbranch_scc1 AF_368
  s_branch AM_372
EA_386:
  s_call_b64 s[80:81], EVH_364
  s_cmp_eq_u32 s79, 0
  s_cbranch_scc1 BM_380
  s_waitcnt vmcnt(4)
  v_pk_fma_f32 v[104:105], v[68:69], v[8:9], v[12:13] op_sel:[1,0,0] op_sel_hi:[1,1,1]
  v_pk_fma_f32 v[106:107], v[68:69], v[10:11], v[14:15] op_sel:[1,0,0] op_sel_hi:[1,1,1]
  v_mfma_f32_4x4x4_16b_bf16 v[112:115], v[42:43], v[98:99], 0
  s_nop 0
  v_mfma_f32_4x4x4_16b_bf16 v[104:107], v[40:41], v[96:97], v[104:107]
  s_nop 4
  s_cmp_eq_u64 s[72:73], -1
  s_cbranch_scc1 AF_369
  s_branch AM_373
EB_387:
  s_call_b64 s[80:81], EVH_364
  s_cmp_eq_u32 s79, 0
  s_cbranch_scc1 AM_373
  v_pk_fma_f32 v[104:105], v[68:69], v[8:9], v[12:13] op_sel:[1,0,0] op_sel_hi:[1,1,1]
  v_pk_fma_f32 v[106:107], v[68:69], v[10:11], v[14:15] op_sel:[1,0,0] op_sel_hi:[1,1,1]
  v_mfma_f32_4x4x4_16b_bf16 v[112:115], v[42:43], v[98:99], 0
  s_nop 0
  v_mfma_f32_4x4x4_16b_bf16 v[104:107], v[40:41], v[96:97], v[104:107]
  s_nop 4
  s_cmp_eq_u64 s[72:73], -1
  s_cbranch_scc1 AF_369
  s_branch AM_373
EA_388:
  s_call_b64 s[80:81], EVH_364
  s_cmp_eq_u32 s79, 0
  s_cbranch_scc1 BM_381
  s_waitcnt vmcnt(4)
  v_pk_fma_f32 v[104:105], v[56:57], v[8:9], v[12:13] op_sel:[1,0,0] op_sel_hi:[1,1,1]
  v_pk_fma_f32 v[106:107], v[56:57], v[10:11], v[14:15] op_sel:[1,0,0] op_sel_hi:[1,1,1]
  v_mfma_f32_4x4x4_16b_bf16 v[112:115], v[42:43], v[74:75], 0
  s_nop 0
  v_mfma_f32_4x4x4_16b_bf16 v[104:107], v[40:41], v[72:73], v[104:107]
  s_nop 4
  s_cmp_eq_u64 s[72:73], -1
  s_cbranch_scc1 AF_366
  s_branch AM_370
EB_389:
  s_call_b64 s[80:81], EVH_364
  s_cmp_eq_u32 s79, 0
  s_cbranch_scc1 AM_370
  v_pk_fma_f32 v[104:105], v[56:57], v[8:9], v[12:13] op_sel:[1,0,0] op_sel_hi:[1,1,1]
  v_pk_fma_f32 v[106:107], v[56:57], v[10:11], v[14:15] op_sel:[1,0,0] op_sel_hi:[1,1,1]
  v_mfma_f32_4x4x4_16b_bf16 v[112:115], v[42:43], v[74:75], 0
  s_nop 0
  v_mfma_f32_4x4x4_16b_bf16 v[104:107], v[40:41], v[72:73], v[104:107]
  s_nop 4
  s_cmp_eq_u64 s[72:73], -1
  s_cbranch_scc1 AF_366
  s_branch AM_370
EA_390:
  s_call_b64 s[80:81], EVH_364
  s_cmp_eq_u32 s79, 0
  s_cbranch_scc1 BM_378
  s_waitcnt vmcnt(4)
  v_pk_fma_f32 v[104:105], v[60:61], v[8:9], v[12:13] op_sel:[1,0,0] op_sel_hi:[1,1,1]
  v_pk_fma_f32 v[106:107], v[60:61], v[10:11], v[14:15] op_sel:[1,0,0] op_sel_hi:[1,1,1]
  v_mfma_f32_4x4x4_16b_bf16 v[112:115], v[42:43], v[82:83], 0
  s_nop 0
  v_mfma_f32_4x4x4_16b_bf16 v[104:107], v[40:41], v[80:81], v[104:107]
  s_nop 4
  s_cmp_eq_u64 s[72:73], -1
  s_cbranch_scc1 AF_367
  s_branch AM_371
EB_391:
  s_call_b64 s[80:81], EVH_364
  s_cmp_eq_u32 s79, 0
  s_cbranch_scc1 AM_371
  v_pk_fma_f32 v[104:105], v[60:61], v[8:9], v[12:13] op_sel:[1,0,0] op_sel_hi:[1,1,1]
  v_pk_fma_f32 v[106:107], v[60:61], v[10:11], v[14:15] op_sel:[1,0,0] op_sel_hi:[1,1,1]
  v_mfma_f32_4x4x4_16b_bf16 v[112:115], v[42:43], v[82:83], 0
  s_nop 0
  v_mfma_f32_4x4x4_16b_bf16 v[104:107], v[40:41], v[80:81], v[104:107]
  s_nop 4
  s_cmp_eq_u64 s[72:73], -1
  s_cbranch_scc1 AF_367
  s_branch AM_371
EA_392:
  s_call_b64 s[80:81], EVH_364
  s_cmp_eq_u32 s79, 0
  s_cbranch_scc1 BM_379
  s_waitcnt vmcnt(4)
  v_pk_fma_f32 v[104:105], v[64:65], v[8:9], v[12:13] op_sel:[1,0,0] op_sel_hi:[1,1,1]
  v_pk_fma_f32 v[106:107], v[64:65], v[10:11], v[14:15] op_sel:[1,0,0] op_sel_hi:[1,1,1]
  v_mfma_f32_4x4x4_16b_bf16 v[112:115], v[42:43], v[90:91], 0
  s_nop 0
  v_mfma_f32_4x4x4_16b_bf16 v[104:107], v[40:41], v[88:89], v[104:107]
  s_nop 4
  s_cmp_eq_u64 s[72:73], -1
  s_cbranch_scc1 AF_368
  s_branch AM_372
EB_393:
  s_call_b64 s[80:81], EVH_364
  s_cmp_eq_u32 s79, 0
  s_cbranch_scc1 AM_372
  v_pk_fma_f32 v[104:105], v[64:65], v[8:9], v[12:13] op_sel:[1,0,0] op_sel_hi:[1,1,1]
  v_pk_fma_f32 v[106:107], v[64:65], v[10:11], v[14:15] op_sel:[1,0,0] op_sel_hi:[1,1,1]
  v_mfma_f32_4x4x4_16b_bf16 v[112:115], v[42:43], v[90:91], 0
  s_nop 0
  v_mfma_f32_4x4x4_16b_bf16 v[104:107], v[40:41], v[88:89], v[104:107]
  s_nop 4
  s_cmp_eq_u64 s[72:73], -1
  s_cbranch_scc1 AF_368
  s_branch AM_372
EA_394:
  s_call_b64 s[80:81], EVH_364
  s_cmp_eq_u32 s79, 0
  s_cbranch_scc1 BM_380
  s_waitcnt vmcnt(4)
  v_pk_fma_f32 v[104:105], v[68:69], v[8:9], v[12:13] op_sel:[1,0,0] op_sel_hi:[1,1,1]
  v_pk_fma_f32 v[106:107], v[68:69], v[10:11], v[14:15] op_sel:[1,0,0] op_sel_hi:[1,1,1]
  v_mfma_f32_4x4x4_16b_bf16 v[112:115], v[42:43], v[98:99], 0
  s_nop 0
  v_mfma_f32_4x4x4_16b_bf16 v[104:107], v[40:41], v[96:97], v[104:107]
  s_nop 4
  s_cmp_eq_u64 s[72:73], -1
  s_cbranch_scc1 AF_369
  s_branch AM_373
EB_395:
  s_call_b64 s[80:81], EVH_364
  s_cmp_eq_u32 s79, 0
  s_cbranch_scc1 AM_373
  v_pk_fma_f32 v[104:105], v[68:69], v[8:9], v[12:13] op_sel:[1,0,0] op_sel_hi:[1,1,1]
  v_pk_fma_f32 v[106:107], v[68:69], v[10:11], v[14:15] op_sel:[1,0,0] op_sel_hi:[1,1,1]
  v_mfma_f32_4x4x4_16b_bf16 v[112:115], v[42:43], v[98:99], 0
  s_nop 0
  v_mfma_f32_4x4x4_16b_bf16 v[104:107], v[40:41], v[96:97], v[104:107]
  s_nop 4
  s_cmp_eq_u64 s[72:73], -1
  s_cbranch_scc1 AF_369
  s_branch AM_373
EA_396:
  s_call_b64 s[80:81], EVH_364
  s_cmp_eq_u32 s79, 0
  s_cbranch_scc1 BM_381
  s_waitcnt vmcnt(4)
  v_pk_fma_f32 v[104:105], v[56:57], v[8:9], v[12:13] op_sel:[1,0,0] op_sel_hi:[1,1,1]
  v_pk_fma_f32 v[106:107], v[56:57], v[10:11], v[14:15] op_sel:[1,0,0] op_sel_hi:[1,1,1]
  v_mfma_f32_4x4x4_16b_bf16 v[112:115], v[42:43], v[74:75], 0
  s_nop 0
  v_mfma_f32_4x4x4_16b_bf16 v[104:107], v[40:41], v[72:73], v[104:107]
  s_nop 4
  s_cmp_eq_u64 s[72:73], -1
  s_cbranch_scc1 AF_366
  s_branch AM_370
EB_397:
  s_call_b64 s[80:81], EVH_364
  s_cmp_eq_u32 s79, 0
  s_cbranch_scc1 AM_370
  v_pk_fma_f32 v[104:105], v[56:57], v[8:9], v[12:13] op_sel:[1,0,0] op_sel_hi:[1,1,1]
  v_pk_fma_f32 v[106:107], v[56:57], v[10:11], v[14:15] op_sel:[1,0,0] op_sel_hi:[1,1,1]
  v_mfma_f32_4x4x4_16b_bf16 v[112:115], v[42:43], v[74:75], 0
  s_nop 0
  v_mfma_f32_4x4x4_16b_bf16 v[104:107], v[40:41], v[72:73], v[104:107]
  s_nop 4
  s_cmp_eq_u64 s[72:73], -1
  s_cbranch_scc1 AF_366
  s_branch AM_370
EVH_364:
  s_mov_b32 s79, 0
  s_mov_b32 s91, s75
EVL_398:
  s_lshr_b64 s[72:73], s[72:73], 16
  s_cbranch_scc0 QEND_399
  s_mov_b32 s75, s76
  s_mov_b32 s76, s77
  s_mov_b32 s77, s78
  s_cmp_ge_u32 s91, s75
  s_cbranch_scc1 EVL_398
RET_400:
  s_sub_u32 s74, s75, s91
  s_sub_u32 s74, s74, 1
  s_setpc_b64 s[80:81]
QEND_399:
  v_pk_mul_f32 v[124:125], v[20:21], v[16:17]
  v_pk_mul_f32 v[126:127], v[22:23], v[18:19]
  v_pk_fma_f32 v[124:125], v[28:29], s[86:87], v[124:125]
  v_pk_fma_f32 v[126:127], v[30:31], s[86:87], v[126:127]
  v_pk_mul_f32 v[4:5], v[24:25], v[16:17]
  v_pk_mul_f32 v[6:7], v[26:27], v[18:19]
  v_min3_f32 v49, v49, v28, v29
  v_maximum3_f32 v50, v50, v124, v125
  v_min3_f32 v49, v49, v30, v31
  v_maximum3_f32 v50, v50, v126, v127
  v_rcp_f32 v124, v124
  v_rcp_f32 v125, v125
  v_rcp_f32 v126, v126
  v_rcp_f32 v127, v127
  s_nop 0
  v_pk_fma_f32 v[4:5], v[4:5], v[124:125], v[32:33]
  v_pk_fma_f32 v[6:7], v[6:7], v[126:127], v[34:35]
  v_maximum3_f32 v51, v51, |v4|, |v5|
  v_maximum3_f32 v51, v51, |v6|, |v7|
  v_max_f32 v4, 0, v4
  v_max_f32 v5, 0, v5
  v_max_f32 v6, 0, v6
  v_max_f32 v7, 0, v7
  v_pk_fma_f32 v[4:5], v[4:5], s[88:89], v[36:37]
  v_pk_fma_f32 v[6:7], v[6:7], s[88:89], v[38:39]
  v_cvt_pk_bf16_f32 v124, v4, v5
  v_cvt_pk_bf16_f32 v125, v6, v7
  buffer_store_dwordx2 v[124:125], v48, s[40:43], 0 offen nt
  s_mov_b32 s79, 1
SETUP_365:
  s_cmp_eq_u32 s82, 0
  s_cbranch_scc1 WEND_363
  s_sub_u32 s82, s82, 1
  s_cmp_eq_u32 s82, 0
  s_cbranch_scc0 PA_401
  s_setprio 0
  s_branch PB_402
PA_401:
  s_cmp_eq_u32 s82, 1
  s_cbranch_scc0 PB_402
  s_setprio 1
PB_402:
  v_lshl_add_u32 v52, s83, 3, v46
  v_mov_b32 v4, s83
  ds_read_b64 v[52:53], v52 offset:3072
  ds_read_b32 v4, v4 offset:4352
  s_mov_b32 s83, s84
  s_mov_b32 s84, s85
  s_waitcnt lgkmcnt(0)
  v_bfe_u32 v5, v52, 7, 3
  v_xor_b32 v5, v5, v45
  v_lshl_add_u32 v5, v5, 4, v54
  v_add_u32 v5, v5, v52
  ds_read_b128 v[124:127], v5
  ds_read_b128 v[120:123], v5 offset:40960
  v_readfirstlane_b32 s78, v4
  v_add_u32 v48, v53, v47
  v_pk_mov_b32 v[20:21], 0, 0
  v_pk_mov_b32 v[22:23], 0, 0
  s_bfe_u32 s75, s78, 0x80018
  s_bfe_u32 s76, s78, 0x80010
  s_bfe_u32 s77, s78, 0x80008
  s_and_b32 s78, s78, 0xff
  v_pk_mov_b32 v[24:25], 0, 0
  v_pk_mov_b32 v[26:27], 0, 0
  v_pk_mov_b32 v[28:29], 1.0, 1.0
  v_pk_mov_b32 v[30:31], 1.0, 1.0
  s_mov_b64 s[72:73], -1
  s_mov_b32 s91, 0
  s_waitcnt lgkmcnt(0)
  v_mfma_f32_4x4x4_16b_bf16 v[36:39], v[40:41], v[120:121], 0
  v_mfma_f32_4x4x4_16b_bf16 v[32:35], v[42:43], v[122:123], 0
  v_min_f32 v12, -1.0, v124
  v_min_f32 v13, -1.0, v125
  v_min_f32 v14, -1.0, v126
  v_min_f32 v15, -1.0, v127
  v_pk_add_f32 v[16:17], v[12:13], v[124:125] neg_lo:[0,1] neg_hi:[0,1]
  v_pk_add_f32 v[18:19], v[14:15], v[126:127] neg_lo:[0,1] neg_hi:[0,1]
  s_nop 0
  v_exp_f32 v16, v16
  v_exp_f32 v17, v17
  v_exp_f32 v18, v18
  v_exp_f32 v19, v19
  s_cmp_eq_u32 s75, 0
  s_cbranch_scc0 RET_400
EV0_403:
  s_lshr_b64 s[72:73], s[72:73], 16
  s_cbranch_scc0 QEND_399
  s_mov_b32 s75, s76
  s_mov_b32 s76, s77
  s_mov_b32 s77, s78
  s_cmp_eq_u32 s75, 0
  s_cbranch_scc1 EV0_403
  s_branch RET_400
WEND_363:
  v_cmp_eq_f32 vcc, 0, v49
  v_mov_b32 v4, 0x207
  v_cmp_class_f32 s[64:65], v50, v4
  v_cmp_class_f32 s[66:67], v51, v4
  s_nop 1
  s_or_b64 vcc, vcc, s[64:65]
  s_or_b64 vcc, vcc, s[66:67]
  s_cbranch_vccz FIN_207
  v_mov_b32 v4, 0
  v_mov_b32 v5, 8
  ds_or_b32 v4, v5 offset:1024
FIN_207:
  s_waitcnt lgkmcnt(0)
  s_barrier
  v_mov_b32 v4, 0
  ds_read_b32 v5, v4 offset:1024
  s_waitcnt lgkmcnt(0)
  v_readfirstlane_b32 s54, v5
  s_and_b32 s54, s54, 31
  s_cmp_eq_u32 s54, 0
  s_cbranch_scc1 END_206
  s_waitcnt vmcnt(0)
  s_barrier
  v_mbcnt_lo_u32_b32 v1, -1, 0
  v_mbcnt_hi_u32_b32 v1, -1, v1
  v_lshrrev_b32 v14, 2, v1
  v_and_b32 v8, 7, v14
  v_lshrrev_b32 v9, 3, v14
  v_mul_u32_u24 v9, 20480, v9
  v_add_u32 v9, 16384, v9
  v_and_b32 v10, 3, v1
  v_lshlrev_b32 v11, 1, v10
  v_lshlrev_b32 v10, 2, v10
  v_lshl_add_u32 v13, v14, 4, v11
  v_lshlrev_b32 v14, 1, v1
  global_load_ushort v12, v14, s[16:17]
  s_mov_b32 s28, s10
  s_and_b32 s29, s11, 0xffff
  s_mov_b32 s30, 640000
  s_mov_b32 s31, 0x00020000
  s_mov_b32 s32, s8
  s_and_b32 s33, s9, 0xffff
  s_mov_b32 s34, 640000
  s_mov_b32 s35, 0x00020000
  s_mov_b32 s44, s6
  s_and_b32 s45, s7, 0xffff
  s_mov_b32 s46, 320000
  s_mov_b32 s47, 0x00020000
  s_mul_i32 s55, s53, 2560000
  s_add_u32 s55, s55, 4096
  s_add_u32 s56, s26, s55
  s_addc_u32 s57, s27, 0
  s_mov_b32 s36, s56
  s_and_b32 s37, s57, 0xffff
  s_mov_b32 s38, 2560000
  s_mov_b32 s39, 0x00020000
  s_waitcnt vmcnt(0)
  v_lshlrev_b32 v12, 16, v12
  v_mul_f32 v12, 0xbfb8aa3b, v12
  s_mul_i32 s64, s52, 157
  s_sub_u32 s65, 10000, s64
  s_min_u32 s65, s65, 157
  s_mov_b32 s66, 0
SLH_404:
  s_mul_i32 s54, s3, 2560
  s_add_u32 s54, s54, 98304
  v_lshlrev_b32 v14, 4, v1
  v_add_u32 v14, s54, v14
  v_mov_b32 v24, 0
  v_mov_b32 v25, 0
  v_mov_b32 v26, 0
  v_mov_b32 v27, 0
  ds_write_b128 v14, v[24:27]
  ds_write_b128 v14, v[24:27] offset:1024
  s_mov_b32 exec_hi, 0
  ds_write_b128 v14, v[24:27] offset:2048
  s_mov_b64 exec, -1
  s_waitcnt lgkmcnt(0)
  s_barrier
  s_mul_i32 s67, s3, 10000
  s_add_u32 s68, s67, 10000
SLE_405:
  v_add_u32 v14, s67, v1
  v_lshlrev_b32 v15, 1, v14
  v_cmp_gt_u32 s[70:71], s68, v14
  v_lshlrev_b32 v14, 2, v14
  buffer_load_dword v16, v14, s[28:31], 0 offen
  buffer_load_dword v17, v14, s[32:35], 0 offen
  buffer_load_ushort v18, v15, s[44:47], 0 offen
  s_add_u32 s69, s64, s66
  s_waitcnt vmcnt(0)
  v_subrev_u32 v16, s69, v16
  v_cmp_gt_u32 vcc, 80, v16
  s_and_b64 s[70:71], s[70:71], vcc
  v_add_u32 v14, s66, v16
  v_cmp_gt_u32 vcc, s65, v14
  s_and_b64 s[70:71], s[70:71], vcc
  v_lshlrev_b32 v18, 16, v18
SLB_407:
  s_cmp_eq_u64 s[70:71], 0
  s_cbranch_scc1 SLBN_408
  s_ff1_i32_b64 s72, s[70:71]
  s_bitset0_b64 s[70:71], s72
  v_readlane_b32 s73, v16, s72
  v_readlane_b32 s74, v17, s72
  v_readlane_b32 s75, v18, s72
  s_nop 3
  s_min_u32 s74, s74, 9999
  s_lshl_b32 s74, s74, 8
  buffer_load_ushort v20, v13, s[36:39], s74 offen sc1
  buffer_load_ushort v21, v13, s[36:39], s74 offen offset:8 sc1
  s_add_u32 s76, s73, s66
  s_and_b32 s77, s76, 7
  v_xor_b32 v14, s77, v8
  v_lshl_add_u32 v14, v14, 4, v9
  s_lshl_b32 s77, s76, 7
  v_add_u32 v14, s77, v14
  v_add_u32 v14, v14, v10
  ds_read_b32 v19, v14
  s_lshl_b32 s77, s73, 8
  v_lshlrev_b32 v15, 2, v1
  v_add_u32 v15, s77, v15
  s_waitcnt vmcnt(0) lgkmcnt(0)
  v_lshlrev_b32 v20, 16, v20
  v_lshlrev_b32 v21, 16, v21
  v_add_f32 v19, 1.0, v19
  v_fma_f32 v19, s75, v12, v19
  v_add_f32 v19, v19, v20
  v_exp_f32 v19, v19
  s_nop 0
  v_add_f32 v19, 1.0, v19
  v_rcp_f32 v19, v19
  s_nop 0
  v_mul_f32 v21, v19, v21
  v_add_u32 v15, 98304, v15
  ds_add_f32 v15, v19
  ds_add_f32 v15, v21 offset:20480
  s_branch SLB_407
SLBN_408:
  s_add_u32 s67, s67, 64
  s_cmp_lt_u32 s67, s68
  s_cbranch_scc1 SLE_405
  s_waitcnt lgkmcnt(0)
  s_barrier
  s_mov_b32 s73, s3
SLF_409:
  s_add_u32 s76, s73, s66
  s_cmp_ge_u32 s76, s65
  s_cbranch_scc1 SLFN_410
  s_lshl_b32 s77, s73, 8
  v_lshlrev_b32 v15, 2, v1
  v_add_u32 v15, s77, v15
  v_add_u32 v15, 98304, v15
  ds_read_b32 v19, v15
  ds_read_b32 v21, v15 offset:20480
  s_and_b32 s77, s76, 7
  v_xor_b32 v14, s77, v8
  v_lshl_add_u32 v14, v14, 4, v9
  s_lshl_b32 s77, s76, 7
  v_add_u32 v14, s77, v14
  v_add_u32 v14, v14, v11
  ds_read_u16 v20, v14 offset:40960
  ds_read_u16 v16, v14 offset:40968
  s_waitcnt lgkmcnt(0)
  v_add_f32 v19, 0x358637bd, v19
  v_rcp_f32 v19, v19
  v_lshlrev_b32 v20, 16, v20
  v_lshlrev_b32 v16, 16, v16
  v_fma_f32 v21, v21, v19, v16
  v_mul_f32 v17, 0, v21
  v_cmp_lt_f32 vcc, 0, v21
  s_nop 1
  v_cndmask_b32 v21, v17, v21, vcc
  v_add_f32 v21, v21, v20
  v_cvt_pk_bf16_f32 v21, v21, v21
  s_lshl_b32 s77, s76, 9
  v_lshlrev_b32 v14, 1, v1
  buffer_store_short v21, v14, s[40:43], s77 offen
  s_add_u32 s73, s73, 16
  s_cmp_lt_u32 s73, 80
  s_cbranch_scc1 SLF_409
SLFN_410:
  s_waitcnt vmcnt(0) lgkmcnt(0)
  s_barrier
  s_add_u32 s66, s66, 80
  s_cmp_lt_u32 s66, 160
  s_cbranch_scc1 SLH_404
END_206:
  s_endpgm
KCODE_END:
.section .rodata,"a"
.p2align 6
.amdhsa_kernel gather_scatter__edge_featured_mpnn_gatedgcn__graph_kernel
  .amdhsa_next_free_vgpr 128
  .amdhsa_next_free_sgpr 102
  .amdhsa_accum_offset 128
  .amdhsa_group_segment_fixed_size 0
  .amdhsa_kernarg_size 96
  .amdhsa_user_sgpr_count 2
  .amdhsa_user_sgpr_kernarg_segment_ptr 1
  .amdhsa_system_sgpr_workgroup_id_x 1
  .amdhsa_float_denorm_mode_32 0
  .amdhsa_float_denorm_mode_16_64 3
.end_amdhsa_kernel
.text
```
